```python
import torch

def _softmax(x, axis=-1):
    return torch.softmax(x, dim=axis)
def _gelu(x):
    return torch.nn.functional.gelu(x, approximate="tanh")
def _silu(x):
    return torch.nn.functional.silu(x)
def _sigmoid(x):
    return torch.sigmoid(x)
def _layernorm(x, axis=-1, eps=1e-5):
    m = x.mean(dim=axis, keepdim=True)
    v = x.var(dim=axis, keepdim=True, unbiased=False)
    return (x - m) / torch.sqrt(v + eps)
def _scatter_add(tgt, idx, src, axis=0):
    return tgt.clone().index_add_(axis, idx, src)
def _segment_sum(src, seg, n):
    out = torch.zeros((n,) + src.shape[1:], dtype=src.dtype)
    return out.index_add_(0, seg, src)
def _pad(x, pw):
    flat = tuple(v for pair in reversed(pw) for v in pair)
    return torch.nn.functional.pad(x, flat)

kernel_name = 'standalone__weight_only_int_omniquant__prompt'

def setup_inputs():

    _w = (lambda a: (lambda t: t.to(torch.bfloat16) if t.is_floating_point() else t)(torch.as_tensor(a)))
    B, S, D, F = 1, 2048, 1024, 3584
    bits = 3
    G = 128 if 128 > 0 else D
    D = (D // G) * G
    ng = D // G
    qmax = (1 << bits) - 1
    qw = torch.randint(0, qmax + 1, (D, F)).to(torch.int32)
    scales = (torch.abs((lambda *s: torch.randn(*s, dtype=torch.bfloat16) * 0.05)(ng, F)) * 0.05 + 0.01).to(float)
    zeros = torch.randint(0, qmax + 1, (ng, F)).to(float)
    act_scale = (torch.abs((lambda *s: torch.randn(*s, dtype=torch.bfloat16) * 0.05)(D)) * 0.5 + 0.5).to(float)
    return {
        "x": _w((lambda *s: torch.randn(*s, dtype=torch.bfloat16) * 0.05)(B, S, D)),
        "qw": _w(qw),
        "scales": _w(scales),
        "zeros": _w(zeros),
        "act_scale": _w(act_scale),
    }

def reference(x, qw, scales, zeros, act_scale):
    B, S, D = x.shape
    ng, F = scales.shape
    G = D // ng
    s = (lambda x, n, axis: torch.repeat_interleave(x, n, dim=axis))(scales, G, axis=0)
    z = (lambda x, n, axis: torch.repeat_interleave(x, n, dim=axis))(zeros, G, axis=0)
    w = ((lambda x, dt: x.to(dt))(qw, x.dtype) - z) * s
    xs = x * (lambda x, dt: x.to(dt))(act_scale, x.dtype)
    return torch.einsum("bsd,df->bsf", xs, w)
```

```asm
; @launch grid=(224,1,1) block=(512,1,1) lds=163840
.amdgcn_target "amdgcn-amd-amdhsa--gfx950"
.text
.globl standalone__weight_only_int_omniquant__prompt_kernel
.p2align 8
.type standalone__weight_only_int_omniquant__prompt_kernel,@function
standalone__weight_only_int_omniquant__prompt_kernel:
s_load_dwordx8 s[4:11], s[0:1], 0
s_load_dwordx4 s[12:15], s[0:1], 32
s_cmp_ge_u32 s2, 224
s_cbranch_scc1 L_end
v_lshrrev_b32 v1, 6, v0
v_and_b32 v0, 63, v0
s_and_b32 s30, s2, 7
v_readfirstlane_b32 s3, v1
s_lshr_b32 s31, s2, 3
s_and_b32 s28, s30, 1
s_lshl_b32 s28, s28, 2
s_and_b32 s48, s31, 3
s_add_u32 s28, s28, s48
s_lshr_b32 s29, s30, 1
s_mul_i32 s29, s29, 7
s_lshr_b32 s49, s31, 2
s_add_u32 s29, s29, s49
s_add_u32 s48, s48, s49
s_and_b32 s48, s48, 3
s_mov_b32 s96, 1985220658
s_mov_b32 s97, 4273659032
s_cmp_eq_u32 s48, 1
s_cselect_b32 s96, 2555654672, s96
s_cselect_b32 s97, 4275878518, s97
s_cmp_eq_u32 s48, 2
s_cselect_b32 s96, 1417023538, s96
s_cselect_b32 s97, 3707681432, s97
s_cmp_eq_u32 s48, 3
s_cselect_b32 s96, 1980781618, s96
s_cselect_b32 s97, 4275869882, s97
s_lshr_b32 s48, s30, 1
s_xor_b32 s48, s48, s30
s_and_b32 s48, s48, 1
s_mul_i32 s48, s48, 572662306
s_xor_b32 s96, s96, s48
s_xor_b32 s97, s97, s48
s_cmp_ge_u32 s3, 4
s_cbranch_scc1 L_prod
s_setprio 1
v_lshrrev_b32 v1, 4, v0
v_lshlrev_b32 v1, 3, v1
v_add_u32 v1, 1, v1
v_mov_b32 v2, s96
v_mov_b32 v5, s97
v_lshrrev_b32 v2, v1, v2
v_lshrrev_b32 v5, v1, v5
v_and_b32 v1, 7, v2
v_and_b32 v5, 7, v5
v_mul_u32_u24 v1, 7168, v1
v_mul_u32_u24 v5, 7168, v5
v_and_b32 v2, 15, v0
v_lshlrev_b32 v2, 4, v2
v_add_u32 v1, v1, v2
v_add_u32 v5, v5, v2
v_lshrrev_b32 v3, 3, v0
v_lshlrev_b32 v3, 2, v3
v_mov_b32 v2, s96
v_mov_b32 v4, s97
v_lshrrev_b32 v2, v3, v2
v_lshrrev_b32 v4, v3, v4
v_and_b32 v2, 15, v2
v_and_b32 v4, 15, v4
v_lshlrev_b32 v2, 7, v2
v_lshlrev_b32 v4, 7, v4
v_and_b32 v3, 7, v0
v_lshlrev_b32 v3, 4, v3
v_add_u32 v2, v2, v3
v_add_u32 v4, v4, v3
v_lshrrev_b32 v8, 3, v0
v_lshlrev_b32 v8, 11, v8
v_and_b32 v9, 7, v0
v_lshrrev_b32 v10, 4, v0
v_xor_b32 v9, v9, v10
v_lshlrev_b32 v9, 4, v9
v_add_u32 v12, v8, v9
v_xor_b32 v13, 64, v12
s_mov_b32 s40, 0
s_mov_b32 s41, 15360
s_mov_b32 s42, 30720
s_mov_b32 s43, 46080
s_mov_b32 s44, 65536
s_mov_b32 s45, 80896
s_mov_b32 s46, 96256
s_mov_b32 s47, 111616
s_lshl_b32 s56, s3, 13
s_lshl_b32 s51, s29, 8
s_lshl_b32 s49, s3, 11
s_add_u32 s49, s49, 147456
s_mov_b32 m0, s49
s_mov_b32 s27, 0x20000
s_mov_b32 s19, 0x20000
s_lshl_b32 s48, s28, 8
s_lshl_b32 s49, s3, 6
s_add_u32 s57, s48, s49
s_lshl_b32 s48, s57, 11
s_waitcnt lgkmcnt(0)
s_add_u32 s86, s4, s48
s_addc_u32 s87, s5, 0
s_sub_u32 s88, 4194304, s48
s_cmp_eq_u32 s3, 3
s_cbranch_scc1 L_tab_done
s_cmp_eq_u32 s3, 2
s_cbranch_scc1 L_tab_a
s_cmp_eq_u32 s3, 0
s_cselect_b32 s24, s8, s10
s_cselect_b32 s25, s9, s11
s_add_u32 s24, s24, s51
s_addc_u32 s25, s25, 0
s_sub_u32 s26, 57344, s51
buffer_load_dwordx4 v1, s[24:27], 0 offen lds
s_add_u32 m0, m0, 1024
s_nop 0
buffer_load_dwordx4 v5, s[24:27], 0 offen lds
s_branch L_tab_done
L_tab_a:
s_mov_b32 s24, s12
s_mov_b32 s25, s13
s_mov_b32 s26, 2048
buffer_load_dwordx4 v2, s[24:27], 0 offen lds
s_add_u32 m0, m0, 1024
s_nop 0
buffer_load_dwordx4 v4, s[24:27], 0 offen lds
L_tab_done:
v_and_b32 v19, 31, v0
v_lshrrev_b32 v22, 5, v0
s_lshl_b32 s48, s3, 6
v_add_u32 v16, s48, v19
v_lshlrev_b32 v16, 7, v16
v_lshrrev_b32 v17, 1, v0
v_and_b32 v17, 7, v17
v_add_u32 v18, 0, v22
v_xor_b32 v18, v18, v17
v_lshlrev_b32 v18, 4, v18
v_add_u32 v2, v16, v18
v_add_u32 v6, 0x10000, v2
v_add_u32 v18, 2, v22
v_xor_b32 v18, v18, v17
v_lshlrev_b32 v18, 4, v18
v_add_u32 v3, v16, v18
v_add_u32 v7, 0x10000, v3
v_add_u32 v18, 4, v22
v_xor_b32 v18, v18, v17
v_lshlrev_b32 v18, 4, v18
v_add_u32 v4, v16, v18
v_add_u32 v8, 0x10000, v4
v_add_u32 v18, 6, v22
v_xor_b32 v18, v18, v17
v_lshlrev_b32 v18, 4, v18
v_add_u32 v5, v16, v18
v_add_u32 v9, 0x10000, v5
v_lshrrev_b32 v18, 4, v19
v_mul_u32_u24 v18, 12, v18
v_xor_b32 v18, v18, v19
v_lshlrev_b32 v18, 4, v18
v_lshlrev_b32 v17, 11, v22
v_add_u32 v18, v18, v17
v_add_u32 v10, 131072, v18
s_mul_i32 s48, s57, 7168
s_add_u32 s48, s48, s51
s_add_u32 s52, s14, s48
s_addc_u32 s53, s15, 0
s_sub_u32 s54, 14680064, s48
s_mov_b32 s55, 0x20000
s_mov_b32 s32, 0
s_mov_b32 s33, 14336
s_mov_b32 s34, 57344
s_mov_b32 s35, 71680
s_mov_b32 s36, 114688
s_mov_b32 s37, 129024
s_mov_b32 s38, 172032
s_mov_b32 s39, 186368
v_lshrrev_b32 v11, 4, v0
v_and_b32 v11, 1, v11
v_lshlrev_b32 v17, 2, v22
v_add_u32 v11, v11, v17
v_mul_u32_u24 v11, 7168, v11
v_and_b32 v17, 15, v0
v_lshlrev_b32 v17, 4, v17
v_add_u32 v11, v11, v17
s_waitcnt vmcnt(0)
s_barrier
s_bfe_u32 s89, s96, 262144
s_lshl_b32 s90, s89, 7
s_add_u32 s16, s86, s90
s_addc_u32 s17, s87, 0
s_sub_u32 s18, s88, s90
s_add_u32 m0, s56, 0
s_nop 0
buffer_load_dwordx4 v12, s[16:19], s40 offen offset:0  lds
buffer_load_dwordx4 v13, s[16:19], s41 offen offset:1024  lds
buffer_load_dwordx4 v12, s[16:19], s42 offen offset:2048  lds
buffer_load_dwordx4 v13, s[16:19], s43 offen offset:3072  lds
s_add_u32 m0, s56, 4096
s_nop 0
buffer_load_dwordx4 v12, s[16:19], s44 offen offset:0  lds
buffer_load_dwordx4 v13, s[16:19], s45 offen offset:1024  lds
buffer_load_dwordx4 v12, s[16:19], s46 offen offset:2048  lds
buffer_load_dwordx4 v13, s[16:19], s47 offen offset:3072  lds
s_bfe_u32 s89, s96, 262148
s_lshl_b32 s90, s89, 7
s_add_u32 s16, s86, s90
s_addc_u32 s17, s87, 0
s_sub_u32 s18, s88, s90
s_add_u32 m0, s56, 32768
s_nop 0
buffer_load_dwordx4 v12, s[16:19], s40 offen offset:0  lds
buffer_load_dwordx4 v13, s[16:19], s41 offen offset:1024  lds
buffer_load_dwordx4 v12, s[16:19], s42 offen offset:2048  lds
buffer_load_dwordx4 v13, s[16:19], s43 offen offset:3072  lds
s_add_u32 m0, s56, 36864
s_nop 0
buffer_load_dwordx4 v12, s[16:19], s44 offen offset:0  lds
buffer_load_dwordx4 v13, s[16:19], s45 offen offset:1024  lds
buffer_load_dwordx4 v12, s[16:19], s46 offen offset:2048  lds
buffer_load_dwordx4 v13, s[16:19], s47 offen offset:3072  lds
s_waitcnt vmcnt(8)
s_barrier
ds_read_b128 v[16:19], v2 offset:0
ds_read_b128 v[24:27], v10 offset:0
ds_read_b128 v[28:31], v10 offset:512
ds_read_b128 v[32:35], v10 offset:1024
ds_read_b128 v[36:39], v10 offset:1536
ds_read_b128 v[20:23], v2 offset:4096
s_waitcnt lgkmcnt(0)
v_mfma_f32_32x32x16_bf16 v[128:143], v[16:19], v[24:27], 0
ds_read_b128 v[40:43], v3 offset:0
ds_read_b128 v[48:51], v10 offset:4096
v_mfma_f32_32x32x16_bf16 v[144:159], v[16:19], v[28:31], 0
ds_read_b128 v[52:55], v10 offset:4608
ds_read_b128 v[56:59], v10 offset:5120
v_mfma_f32_32x32x16_bf16 v[160:175], v[16:19], v[32:35], 0
ds_read_b128 v[60:63], v10 offset:5632
ds_read_b128 v[44:47], v3 offset:4096
v_mfma_f32_32x32x16_bf16 v[176:191], v[16:19], v[36:39], 0
s_bfe_u32 s89, s96, 262152
s_lshl_b32 s90, s89, 7
s_add_u32 s16, s86, s90
s_addc_u32 s17, s87, 0
s_sub_u32 s18, s88, s90
s_add_u32 m0, s56, 65536
s_nop 0
buffer_load_dwordx4 v12, s[16:19], s40 offen offset:0  lds
v_mfma_f32_32x32x16_bf16 v[240:255], v[20:23], v[36:39], 0
v_mfma_f32_32x32x16_bf16 v[224:239], v[20:23], v[32:35], 0
buffer_load_dwordx4 v13, s[16:19], s41 offen offset:1024  lds
v_mfma_f32_32x32x16_bf16 v[208:223], v[20:23], v[28:31], 0
v_mfma_f32_32x32x16_bf16 v[192:207], v[20:23], v[24:27], 0
s_waitcnt lgkmcnt(0)
v_mfma_f32_32x32x16_bf16 v[128:143], v[40:43], v[48:51], v[128:143]
ds_read_b128 v[16:19], v4 offset:0
ds_read_b128 v[24:27], v10 offset:8192
v_mfma_f32_32x32x16_bf16 v[144:159], v[40:43], v[52:55], v[144:159]
ds_read_b128 v[28:31], v10 offset:8704
ds_read_b128 v[32:35], v10 offset:9216
v_mfma_f32_32x32x16_bf16 v[160:175], v[40:43], v[56:59], v[160:175]
ds_read_b128 v[36:39], v10 offset:9728
ds_read_b128 v[20:23], v4 offset:4096
v_mfma_f32_32x32x16_bf16 v[176:191], v[40:43], v[60:63], v[176:191]
buffer_load_dwordx4 v12, s[16:19], s42 offen offset:2048  lds
v_mfma_f32_32x32x16_bf16 v[240:255], v[44:47], v[60:63], v[240:255]
v_mfma_f32_32x32x16_bf16 v[224:239], v[44:47], v[56:59], v[224:239]
buffer_load_dwordx4 v13, s[16:19], s43 offen offset:3072  lds
v_mfma_f32_32x32x16_bf16 v[208:223], v[44:47], v[52:55], v[208:223]
v_mfma_f32_32x32x16_bf16 v[192:207], v[44:47], v[48:51], v[192:207]
s_waitcnt lgkmcnt(0)
v_mfma_f32_32x32x16_bf16 v[128:143], v[16:19], v[24:27], v[128:143]
ds_read_b128 v[40:43], v5 offset:0
ds_read_b128 v[48:51], v10 offset:12288
v_mfma_f32_32x32x16_bf16 v[144:159], v[16:19], v[28:31], v[144:159]
ds_read_b128 v[52:55], v10 offset:12800
ds_read_b128 v[56:59], v10 offset:13312
v_mfma_f32_32x32x16_bf16 v[160:175], v[16:19], v[32:35], v[160:175]
ds_read_b128 v[60:63], v10 offset:13824
ds_read_b128 v[44:47], v5 offset:4096
v_mfma_f32_32x32x16_bf16 v[176:191], v[16:19], v[36:39], v[176:191]
s_add_u32 m0, s56, 69632
s_nop 0
buffer_load_dwordx4 v12, s[16:19], s44 offen offset:0  lds
v_mfma_f32_32x32x16_bf16 v[240:255], v[20:23], v[36:39], v[240:255]
v_mfma_f32_32x32x16_bf16 v[224:239], v[20:23], v[32:35], v[224:239]
buffer_load_dwordx4 v13, s[16:19], s45 offen offset:1024  lds
v_mfma_f32_32x32x16_bf16 v[208:223], v[20:23], v[28:31], v[208:223]
v_mfma_f32_32x32x16_bf16 v[192:207], v[20:23], v[24:27], v[192:207]
s_waitcnt lgkmcnt(0)
s_waitcnt vmcnt(6)
s_barrier
v_mfma_f32_32x32x16_bf16 v[128:143], v[40:43], v[48:51], v[128:143]
ds_read_b128 v[16:19], v2 offset:32768
ds_read_b128 v[24:27], v10 offset:16384
v_mfma_f32_32x32x16_bf16 v[144:159], v[40:43], v[52:55], v[144:159]
ds_read_b128 v[28:31], v10 offset:16896
ds_read_b128 v[32:35], v10 offset:17408
v_mfma_f32_32x32x16_bf16 v[160:175], v[40:43], v[56:59], v[160:175]
ds_read_b128 v[36:39], v10 offset:17920
ds_read_b128 v[20:23], v2 offset:36864
v_mfma_f32_32x32x16_bf16 v[176:191], v[40:43], v[60:63], v[176:191]
buffer_load_dwordx4 v12, s[16:19], s46 offen offset:2048  lds
v_mfma_f32_32x32x16_bf16 v[240:255], v[44:47], v[60:63], v[240:255]
v_mfma_f32_32x32x16_bf16 v[224:239], v[44:47], v[56:59], v[224:239]
buffer_load_dwordx4 v13, s[16:19], s47 offen offset:3072  lds
v_mfma_f32_32x32x16_bf16 v[208:223], v[44:47], v[52:55], v[208:223]
v_mfma_f32_32x32x16_bf16 v[192:207], v[44:47], v[48:51], v[192:207]
s_waitcnt lgkmcnt(0)
v_mfma_f32_32x32x16_bf16 v[128:143], v[16:19], v[24:27], v[128:143]
ds_read_b128 v[40:43], v3 offset:32768
ds_read_b128 v[48:51], v10 offset:20480
v_mfma_f32_32x32x16_bf16 v[144:159], v[16:19], v[28:31], v[144:159]
ds_read_b128 v[52:55], v10 offset:20992
ds_read_b128 v[56:59], v10 offset:21504
v_mfma_f32_32x32x16_bf16 v[160:175], v[16:19], v[32:35], v[160:175]
ds_read_b128 v[60:63], v10 offset:22016
ds_read_b128 v[44:47], v3 offset:36864
v_mfma_f32_32x32x16_bf16 v[176:191], v[16:19], v[36:39], v[176:191]
s_bfe_u32 s89, s96, 262156
s_lshl_b32 s90, s89, 7
s_add_u32 s16, s86, s90
s_addc_u32 s17, s87, 0
s_sub_u32 s18, s88, s90
s_add_u32 m0, s56, 98304
s_nop 0
buffer_load_dwordx4 v12, s[16:19], s40 offen offset:0  lds
v_mfma_f32_32x32x16_bf16 v[240:255], v[20:23], v[36:39], v[240:255]
v_mfma_f32_32x32x16_bf16 v[224:239], v[20:23], v[32:35], v[224:239]
buffer_load_dwordx4 v13, s[16:19], s41 offen offset:1024  lds
v_mfma_f32_32x32x16_bf16 v[208:223], v[20:23], v[28:31], v[208:223]
v_mfma_f32_32x32x16_bf16 v[192:207], v[20:23], v[24:27], v[192:207]
s_waitcnt lgkmcnt(0)
v_mfma_f32_32x32x16_bf16 v[128:143], v[40:43], v[48:51], v[128:143]
ds_read_b128 v[16:19], v4 offset:32768
ds_read_b128 v[24:27], v10 offset:24576
v_mfma_f32_32x32x16_bf16 v[144:159], v[40:43], v[52:55], v[144:159]
ds_read_b128 v[28:31], v10 offset:25088
ds_read_b128 v[32:35], v10 offset:25600
v_mfma_f32_32x32x16_bf16 v[160:175], v[40:43], v[56:59], v[160:175]
ds_read_b128 v[36:39], v10 offset:26112
ds_read_b128 v[20:23], v4 offset:36864
v_mfma_f32_32x32x16_bf16 v[176:191], v[40:43], v[60:63], v[176:191]
buffer_load_dwordx4 v12, s[16:19], s42 offen offset:2048  lds
v_mfma_f32_32x32x16_bf16 v[240:255], v[44:47], v[60:63], v[240:255]
v_mfma_f32_32x32x16_bf16 v[224:239], v[44:47], v[56:59], v[224:239]
buffer_load_dwordx4 v13, s[16:19], s43 offen offset:3072  lds
v_mfma_f32_32x32x16_bf16 v[208:223], v[44:47], v[52:55], v[208:223]
v_mfma_f32_32x32x16_bf16 v[192:207], v[44:47], v[48:51], v[192:207]
s_waitcnt lgkmcnt(0)
v_mfma_f32_32x32x16_bf16 v[128:143], v[16:19], v[24:27], v[128:143]
ds_read_b128 v[40:43], v5 offset:32768
ds_read_b128 v[48:51], v10 offset:28672
v_mfma_f32_32x32x16_bf16 v[144:159], v[16:19], v[28:31], v[144:159]
ds_read_b128 v[52:55], v10 offset:29184
ds_read_b128 v[56:59], v10 offset:29696
v_mfma_f32_32x32x16_bf16 v[160:175], v[16:19], v[32:35], v[160:175]
ds_read_b128 v[60:63], v10 offset:30208
ds_read_b128 v[44:47], v5 offset:36864
v_mfma_f32_32x32x16_bf16 v[176:191], v[16:19], v[36:39], v[176:191]
s_add_u32 m0, s56, 102400
s_nop 0
buffer_load_dwordx4 v12, s[16:19], s44 offen offset:0  lds
v_mfma_f32_32x32x16_bf16 v[240:255], v[20:23], v[36:39], v[240:255]
v_mfma_f32_32x32x16_bf16 v[224:239], v[20:23], v[32:35], v[224:239]
buffer_load_dwordx4 v13, s[16:19], s45 offen offset:1024  lds
v_mfma_f32_32x32x16_bf16 v[208:223], v[20:23], v[28:31], v[208:223]
v_mfma_f32_32x32x16_bf16 v[192:207], v[20:23], v[24:27], v[192:207]
s_waitcnt lgkmcnt(0)
s_waitcnt vmcnt(6)
s_barrier
v_mfma_f32_32x32x16_bf16 v[128:143], v[40:43], v[48:51], v[128:143]
ds_read_b128 v[16:19], v6 offset:0
ds_read_b128 v[24:27], v10 offset:0
v_mfma_f32_32x32x16_bf16 v[144:159], v[40:43], v[52:55], v[144:159]
ds_read_b128 v[28:31], v10 offset:512
ds_read_b128 v[32:35], v10 offset:1024
v_mfma_f32_32x32x16_bf16 v[160:175], v[40:43], v[56:59], v[160:175]
ds_read_b128 v[36:39], v10 offset:1536
ds_read_b128 v[20:23], v6 offset:4096
v_mfma_f32_32x32x16_bf16 v[176:191], v[40:43], v[60:63], v[176:191]
buffer_load_dwordx4 v12, s[16:19], s46 offen offset:2048  lds
v_mfma_f32_32x32x16_bf16 v[240:255], v[44:47], v[60:63], v[240:255]
v_mfma_f32_32x32x16_bf16 v[224:239], v[44:47], v[56:59], v[224:239]
buffer_load_dwordx4 v13, s[16:19], s47 offen offset:3072  lds
v_mfma_f32_32x32x16_bf16 v[208:223], v[44:47], v[52:55], v[208:223]
v_mfma_f32_32x32x16_bf16 v[192:207], v[44:47], v[48:51], v[192:207]
s_waitcnt lgkmcnt(0)
v_mfma_f32_32x32x16_bf16 v[128:143], v[16:19], v[24:27], v[128:143]
ds_read_b128 v[40:43], v7 offset:0
ds_read_b128 v[48:51], v10 offset:4096
v_mfma_f32_32x32x16_bf16 v[144:159], v[16:19], v[28:31], v[144:159]
ds_read_b128 v[52:55], v10 offset:4608
ds_read_b128 v[56:59], v10 offset:5120
v_mfma_f32_32x32x16_bf16 v[160:175], v[16:19], v[32:35], v[160:175]
ds_read_b128 v[60:63], v10 offset:5632
ds_read_b128 v[44:47], v7 offset:4096
v_mfma_f32_32x32x16_bf16 v[176:191], v[16:19], v[36:39], v[176:191]
s_bfe_u32 s89, s96, 262160
s_lshl_b32 s90, s89, 7
s_add_u32 s16, s86, s90
s_addc_u32 s17, s87, 0
s_sub_u32 s18, s88, s90
s_add_u32 m0, s56, 0
s_nop 0
buffer_load_dwordx4 v12, s[16:19], s40 offen offset:0  lds
v_mfma_f32_32x32x16_bf16 v[240:255], v[20:23], v[36:39], v[240:255]
v_mfma_f32_32x32x16_bf16 v[224:239], v[20:23], v[32:35], v[224:239]
buffer_load_dwordx4 v13, s[16:19], s41 offen offset:1024  lds
v_mfma_f32_32x32x16_bf16 v[208:223], v[20:23], v[28:31], v[208:223]
v_mfma_f32_32x32x16_bf16 v[192:207], v[20:23], v[24:27], v[192:207]
s_waitcnt lgkmcnt(0)
v_mfma_f32_32x32x16_bf16 v[128:143], v[40:43], v[48:51], v[128:143]
ds_read_b128 v[16:19], v8 offset:0
ds_read_b128 v[24:27], v10 offset:8192
v_mfma_f32_32x32x16_bf16 v[144:159], v[40:43], v[52:55], v[144:159]
ds_read_b128 v[28:31], v10 offset:8704
ds_read_b128 v[32:35], v10 offset:9216
v_mfma_f32_32x32x16_bf16 v[160:175], v[40:43], v[56:59], v[160:175]
ds_read_b128 v[36:39], v10 offset:9728
ds_read_b128 v[20:23], v8 offset:4096
v_mfma_f32_32x32x16_bf16 v[176:191], v[40:43], v[60:63], v[176:191]
buffer_load_dwordx4 v12, s[16:19], s42 offen offset:2048  lds
v_mfma_f32_32x32x16_bf16 v[240:255], v[44:47], v[60:63], v[240:255]
v_mfma_f32_32x32x16_bf16 v[224:239], v[44:47], v[56:59], v[224:239]
buffer_load_dwordx4 v13, s[16:19], s43 offen offset:3072  lds
v_mfma_f32_32x32x16_bf16 v[208:223], v[44:47], v[52:55], v[208:223]
v_mfma_f32_32x32x16_bf16 v[192:207], v[44:47], v[48:51], v[192:207]
s_waitcnt lgkmcnt(0)
v_mfma_f32_32x32x16_bf16 v[128:143], v[16:19], v[24:27], v[128:143]
ds_read_b128 v[40:43], v9 offset:0
ds_read_b128 v[48:51], v10 offset:12288
v_mfma_f32_32x32x16_bf16 v[144:159], v[16:19], v[28:31], v[144:159]
ds_read_b128 v[52:55], v10 offset:12800
ds_read_b128 v[56:59], v10 offset:13312
v_mfma_f32_32x32x16_bf16 v[160:175], v[16:19], v[32:35], v[160:175]
ds_read_b128 v[60:63], v10 offset:13824
ds_read_b128 v[44:47], v9 offset:4096
v_mfma_f32_32x32x16_bf16 v[176:191], v[16:19], v[36:39], v[176:191]
s_add_u32 m0, s56, 4096
s_nop 0
buffer_load_dwordx4 v12, s[16:19], s44 offen offset:0  lds
v_mfma_f32_32x32x16_bf16 v[240:255], v[20:23], v[36:39], v[240:255]
v_mfma_f32_32x32x16_bf16 v[224:239], v[20:23], v[32:35], v[224:239]
buffer_load_dwordx4 v13, s[16:19], s45 offen offset:1024  lds
v_mfma_f32_32x32x16_bf16 v[208:223], v[20:23], v[28:31], v[208:223]
v_mfma_f32_32x32x16_bf16 v[192:207], v[20:23], v[24:27], v[192:207]
s_waitcnt lgkmcnt(0)
s_waitcnt vmcnt(6)
s_barrier
v_mfma_f32_32x32x16_bf16 v[128:143], v[40:43], v[48:51], v[128:143]
ds_read_b128 v[16:19], v6 offset:32768
ds_read_b128 v[24:27], v10 offset:16384
v_mfma_f32_32x32x16_bf16 v[144:159], v[40:43], v[52:55], v[144:159]
ds_read_b128 v[28:31], v10 offset:16896
ds_read_b128 v[32:35], v10 offset:17408
v_mfma_f32_32x32x16_bf16 v[160:175], v[40:43], v[56:59], v[160:175]
ds_read_b128 v[36:39], v10 offset:17920
ds_read_b128 v[20:23], v6 offset:36864
v_mfma_f32_32x32x16_bf16 v[176:191], v[40:43], v[60:63], v[176:191]
buffer_load_dwordx4 v12, s[16:19], s46 offen offset:2048  lds
v_mfma_f32_32x32x16_bf16 v[240:255], v[44:47], v[60:63], v[240:255]
v_mfma_f32_32x32x16_bf16 v[224:239], v[44:47], v[56:59], v[224:239]
buffer_load_dwordx4 v13, s[16:19], s47 offen offset:3072  lds
v_mfma_f32_32x32x16_bf16 v[208:223], v[44:47], v[52:55], v[208:223]
v_mfma_f32_32x32x16_bf16 v[192:207], v[44:47], v[48:51], v[192:207]
s_waitcnt lgkmcnt(0)
v_mfma_f32_32x32x16_bf16 v[128:143], v[16:19], v[24:27], v[128:143]
ds_read_b128 v[40:43], v7 offset:32768
ds_read_b128 v[48:51], v10 offset:20480
v_mfma_f32_32x32x16_bf16 v[144:159], v[16:19], v[28:31], v[144:159]
ds_read_b128 v[52:55], v10 offset:20992
ds_read_b128 v[56:59], v10 offset:21504
v_mfma_f32_32x32x16_bf16 v[160:175], v[16:19], v[32:35], v[160:175]
ds_read_b128 v[60:63], v10 offset:22016
ds_read_b128 v[44:47], v7 offset:36864
v_mfma_f32_32x32x16_bf16 v[176:191], v[16:19], v[36:39], v[176:191]
s_bfe_u32 s89, s96, 262164
s_lshl_b32 s90, s89, 7
s_add_u32 s16, s86, s90
s_addc_u32 s17, s87, 0
s_sub_u32 s18, s88, s90
s_add_u32 m0, s56, 32768
s_nop 0
buffer_load_dwordx4 v12, s[16:19], s40 offen offset:0  lds
v_mfma_f32_32x32x16_bf16 v[240:255], v[20:23], v[36:39], v[240:255]
v_mfma_f32_32x32x16_bf16 v[224:239], v[20:23], v[32:35], v[224:239]
buffer_load_dwordx4 v13, s[16:19], s41 offen offset:1024  lds
v_mfma_f32_32x32x16_bf16 v[208:223], v[20:23], v[28:31], v[208:223]
v_mfma_f32_32x32x16_bf16 v[192:207], v[20:23], v[24:27], v[192:207]
s_waitcnt lgkmcnt(0)
v_mfma_f32_32x32x16_bf16 v[128:143], v[40:43], v[48:51], v[128:143]
ds_read_b128 v[16:19], v8 offset:32768
ds_read_b128 v[24:27], v10 offset:24576
v_mfma_f32_32x32x16_bf16 v[144:159], v[40:43], v[52:55], v[144:159]
ds_read_b128 v[28:31], v10 offset:25088
ds_read_b128 v[32:35], v10 offset:25600
v_mfma_f32_32x32x16_bf16 v[160:175], v[40:43], v[56:59], v[160:175]
ds_read_b128 v[36:39], v10 offset:26112
ds_read_b128 v[20:23], v8 offset:36864
v_mfma_f32_32x32x16_bf16 v[176:191], v[40:43], v[60:63], v[176:191]
buffer_load_dwordx4 v12, s[16:19], s42 offen offset:2048  lds
v_mfma_f32_32x32x16_bf16 v[240:255], v[44:47], v[60:63], v[240:255]
v_mfma_f32_32x32x16_bf16 v[224:239], v[44:47], v[56:59], v[224:239]
buffer_load_dwordx4 v13, s[16:19], s43 offen offset:3072  lds
v_mfma_f32_32x32x16_bf16 v[208:223], v[44:47], v[52:55], v[208:223]
v_mfma_f32_32x32x16_bf16 v[192:207], v[44:47], v[48:51], v[192:207]
s_waitcnt lgkmcnt(0)
v_mfma_f32_32x32x16_bf16 v[128:143], v[16:19], v[24:27], v[128:143]
ds_read_b128 v[40:43], v9 offset:32768
ds_read_b128 v[48:51], v10 offset:28672
v_mfma_f32_32x32x16_bf16 v[144:159], v[16:19], v[28:31], v[144:159]
ds_read_b128 v[52:55], v10 offset:29184
ds_read_b128 v[56:59], v10 offset:29696
v_mfma_f32_32x32x16_bf16 v[160:175], v[16:19], v[32:35], v[160:175]
ds_read_b128 v[60:63], v10 offset:30208
ds_read_b128 v[44:47], v9 offset:36864
v_mfma_f32_32x32x16_bf16 v[176:191], v[16:19], v[36:39], v[176:191]
s_add_u32 m0, s56, 36864
s_nop 0
buffer_load_dwordx4 v12, s[16:19], s44 offen offset:0  lds
v_mfma_f32_32x32x16_bf16 v[240:255], v[20:23], v[36:39], v[240:255]
v_mfma_f32_32x32x16_bf16 v[224:239], v[20:23], v[32:35], v[224:239]
buffer_load_dwordx4 v13, s[16:19], s45 offen offset:1024  lds
v_mfma_f32_32x32x16_bf16 v[208:223], v[20:23], v[28:31], v[208:223]
v_mfma_f32_32x32x16_bf16 v[192:207], v[20:23], v[24:27], v[192:207]
s_waitcnt lgkmcnt(0)
s_waitcnt vmcnt(6)
s_barrier
v_mfma_f32_32x32x16_bf16 v[128:143], v[40:43], v[48:51], v[128:143]
ds_read_b128 v[16:19], v2 offset:0
ds_read_b128 v[24:27], v10 offset:0
v_mfma_f32_32x32x16_bf16 v[144:159], v[40:43], v[52:55], v[144:159]
ds_read_b128 v[28:31], v10 offset:512
ds_read_b128 v[32:35], v10 offset:1024
v_mfma_f32_32x32x16_bf16 v[160:175], v[40:43], v[56:59], v[160:175]
ds_read_b128 v[36:39], v10 offset:1536
ds_read_b128 v[20:23], v2 offset:4096
v_mfma_f32_32x32x16_bf16 v[176:191], v[40:43], v[60:63], v[176:191]
buffer_load_dwordx4 v12, s[16:19], s46 offen offset:2048  lds
v_mfma_f32_32x32x16_bf16 v[240:255], v[44:47], v[60:63], v[240:255]
v_mfma_f32_32x32x16_bf16 v[224:239], v[44:47], v[56:59], v[224:239]
buffer_load_dwordx4 v13, s[16:19], s47 offen offset:3072  lds
v_mfma_f32_32x32x16_bf16 v[208:223], v[44:47], v[52:55], v[208:223]
v_mfma_f32_32x32x16_bf16 v[192:207], v[44:47], v[48:51], v[192:207]
s_waitcnt lgkmcnt(0)
v_mfma_f32_32x32x16_bf16 v[128:143], v[16:19], v[24:27], v[128:143]
ds_read_b128 v[40:43], v3 offset:0
ds_read_b128 v[48:51], v10 offset:4096
v_mfma_f32_32x32x16_bf16 v[144:159], v[16:19], v[28:31], v[144:159]
ds_read_b128 v[52:55], v10 offset:4608
ds_read_b128 v[56:59], v10 offset:5120
v_mfma_f32_32x32x16_bf16 v[160:175], v[16:19], v[32:35], v[160:175]
ds_read_b128 v[60:63], v10 offset:5632
ds_read_b128 v[44:47], v3 offset:4096
v_mfma_f32_32x32x16_bf16 v[176:191], v[16:19], v[36:39], v[176:191]
s_bfe_u32 s89, s96, 262168
s_lshl_b32 s90, s89, 7
s_add_u32 s16, s86, s90
s_addc_u32 s17, s87, 0
s_sub_u32 s18, s88, s90
s_add_u32 m0, s56, 65536
s_nop 0
buffer_load_dwordx4 v12, s[16:19], s40 offen offset:0  lds
v_mfma_f32_32x32x16_bf16 v[240:255], v[20:23], v[36:39], v[240:255]
v_mfma_f32_32x32x16_bf16 v[224:239], v[20:23], v[32:35], v[224:239]
buffer_load_dwordx4 v13, s[16:19], s41 offen offset:1024  lds
v_mfma_f32_32x32x16_bf16 v[208:223], v[20:23], v[28:31], v[208:223]
v_mfma_f32_32x32x16_bf16 v[192:207], v[20:23], v[24:27], v[192:207]
s_waitcnt lgkmcnt(0)
v_mfma_f32_32x32x16_bf16 v[128:143], v[40:43], v[48:51], v[128:143]
ds_read_b128 v[16:19], v4 offset:0
ds_read_b128 v[24:27], v10 offset:8192
v_mfma_f32_32x32x16_bf16 v[144:159], v[40:43], v[52:55], v[144:159]
ds_read_b128 v[28:31], v10 offset:8704
ds_read_b128 v[32:35], v10 offset:9216
v_mfma_f32_32x32x16_bf16 v[160:175], v[40:43], v[56:59], v[160:175]
ds_read_b128 v[36:39], v10 offset:9728
ds_read_b128 v[20:23], v4 offset:4096
v_mfma_f32_32x32x16_bf16 v[176:191], v[40:43], v[60:63], v[176:191]
buffer_load_dwordx4 v12, s[16:19], s42 offen offset:2048  lds
v_mfma_f32_32x32x16_bf16 v[240:255], v[44:47], v[60:63], v[240:255]
v_mfma_f32_32x32x16_bf16 v[224:239], v[44:47], v[56:59], v[224:239]
buffer_load_dwordx4 v13, s[16:19], s43 offen offset:3072  lds
v_mfma_f32_32x32x16_bf16 v[208:223], v[44:47], v[52:55], v[208:223]
v_mfma_f32_32x32x16_bf16 v[192:207], v[44:47], v[48:51], v[192:207]
s_waitcnt lgkmcnt(0)
v_mfma_f32_32x32x16_bf16 v[128:143], v[16:19], v[24:27], v[128:143]
ds_read_b128 v[40:43], v5 offset:0
ds_read_b128 v[48:51], v10 offset:12288
v_mfma_f32_32x32x16_bf16 v[144:159], v[16:19], v[28:31], v[144:159]
ds_read_b128 v[52:55], v10 offset:12800
ds_read_b128 v[56:59], v10 offset:13312
v_mfma_f32_32x32x16_bf16 v[160:175], v[16:19], v[32:35], v[160:175]
ds_read_b128 v[60:63], v10 offset:13824
ds_read_b128 v[44:47], v5 offset:4096
v_mfma_f32_32x32x16_bf16 v[176:191], v[16:19], v[36:39], v[176:191]
s_add_u32 m0, s56, 69632
s_nop 0
buffer_load_dwordx4 v12, s[16:19], s44 offen offset:0  lds
v_mfma_f32_32x32x16_bf16 v[240:255], v[20:23], v[36:39], v[240:255]
v_mfma_f32_32x32x16_bf16 v[224:239], v[20:23], v[32:35], v[224:239]
buffer_load_dwordx4 v13, s[16:19], s45 offen offset:1024  lds
v_mfma_f32_32x32x16_bf16 v[208:223], v[20:23], v[28:31], v[208:223]
v_mfma_f32_32x32x16_bf16 v[192:207], v[20:23], v[24:27], v[192:207]
s_waitcnt lgkmcnt(0)
s_waitcnt vmcnt(6)
s_barrier
v_mfma_f32_32x32x16_bf16 v[128:143], v[40:43], v[48:51], v[128:143]
ds_read_b128 v[16:19], v2 offset:32768
ds_read_b128 v[24:27], v10 offset:16384
v_mfma_f32_32x32x16_bf16 v[144:159], v[40:43], v[52:55], v[144:159]
ds_read_b128 v[28:31], v10 offset:16896
ds_read_b128 v[32:35], v10 offset:17408
v_mfma_f32_32x32x16_bf16 v[160:175], v[40:43], v[56:59], v[160:175]
ds_read_b128 v[36:39], v10 offset:17920
ds_read_b128 v[20:23], v2 offset:36864
v_mfma_f32_32x32x16_bf16 v[176:191], v[40:43], v[60:63], v[176:191]
buffer_load_dwordx4 v12, s[16:19], s46 offen offset:2048  lds
v_mfma_f32_32x32x16_bf16 v[240:255], v[44:47], v[60:63], v[240:255]
v_mfma_f32_32x32x16_bf16 v[224:239], v[44:47], v[56:59], v[224:239]
buffer_load_dwordx4 v13, s[16:19], s47 offen offset:3072  lds
v_mfma_f32_32x32x16_bf16 v[208:223], v[44:47], v[52:55], v[208:223]
v_mfma_f32_32x32x16_bf16 v[192:207], v[44:47], v[48:51], v[192:207]
s_waitcnt lgkmcnt(0)
v_mfma_f32_32x32x16_bf16 v[128:143], v[16:19], v[24:27], v[128:143]
ds_read_b128 v[40:43], v3 offset:32768
ds_read_b128 v[48:51], v10 offset:20480
v_mfma_f32_32x32x16_bf16 v[144:159], v[16:19], v[28:31], v[144:159]
ds_read_b128 v[52:55], v10 offset:20992
ds_read_b128 v[56:59], v10 offset:21504
v_mfma_f32_32x32x16_bf16 v[160:175], v[16:19], v[32:35], v[160:175]
ds_read_b128 v[60:63], v10 offset:22016
ds_read_b128 v[44:47], v3 offset:36864
v_mfma_f32_32x32x16_bf16 v[176:191], v[16:19], v[36:39], v[176:191]
s_bfe_u32 s89, s96, 262172
s_lshl_b32 s90, s89, 7
s_add_u32 s16, s86, s90
s_addc_u32 s17, s87, 0
s_sub_u32 s18, s88, s90
s_add_u32 m0, s56, 98304
s_nop 0
buffer_load_dwordx4 v12, s[16:19], s40 offen offset:0  lds
v_mfma_f32_32x32x16_bf16 v[240:255], v[20:23], v[36:39], v[240:255]
v_mfma_f32_32x32x16_bf16 v[224:239], v[20:23], v[32:35], v[224:239]
buffer_load_dwordx4 v13, s[16:19], s41 offen offset:1024  lds
v_mfma_f32_32x32x16_bf16 v[208:223], v[20:23], v[28:31], v[208:223]
v_mfma_f32_32x32x16_bf16 v[192:207], v[20:23], v[24:27], v[192:207]
s_waitcnt lgkmcnt(0)
v_mfma_f32_32x32x16_bf16 v[128:143], v[40:43], v[48:51], v[128:143]
ds_read_b128 v[16:19], v4 offset:32768
ds_read_b128 v[24:27], v10 offset:24576
v_mfma_f32_32x32x16_bf16 v[144:159], v[40:43], v[52:55], v[144:159]
ds_read_b128 v[28:31], v10 offset:25088
ds_read_b128 v[32:35], v10 offset:25600
v_mfma_f32_32x32x16_bf16 v[160:175], v[40:43], v[56:59], v[160:175]
ds_read_b128 v[36:39], v10 offset:26112
ds_read_b128 v[20:23], v4 offset:36864
v_mfma_f32_32x32x16_bf16 v[176:191], v[40:43], v[60:63], v[176:191]
buffer_load_dwordx4 v12, s[16:19], s42 offen offset:2048  lds
v_mfma_f32_32x32x16_bf16 v[240:255], v[44:47], v[60:63], v[240:255]
v_mfma_f32_32x32x16_bf16 v[224:239], v[44:47], v[56:59], v[224:239]
buffer_load_dwordx4 v13, s[16:19], s43 offen offset:3072  lds
v_mfma_f32_32x32x16_bf16 v[208:223], v[44:47], v[52:55], v[208:223]
v_mfma_f32_32x32x16_bf16 v[192:207], v[44:47], v[48:51], v[192:207]
s_waitcnt lgkmcnt(0)
v_mfma_f32_32x32x16_bf16 v[128:143], v[16:19], v[24:27], v[128:143]
ds_read_b128 v[40:43], v5 offset:32768
ds_read_b128 v[48:51], v10 offset:28672
v_mfma_f32_32x32x16_bf16 v[144:159], v[16:19], v[28:31], v[144:159]
ds_read_b128 v[52:55], v10 offset:29184
ds_read_b128 v[56:59], v10 offset:29696
v_mfma_f32_32x32x16_bf16 v[160:175], v[16:19], v[32:35], v[160:175]
ds_read_b128 v[60:63], v10 offset:30208
ds_read_b128 v[44:47], v5 offset:36864
v_mfma_f32_32x32x16_bf16 v[176:191], v[16:19], v[36:39], v[176:191]
s_add_u32 m0, s56, 102400
s_nop 0
buffer_load_dwordx4 v12, s[16:19], s44 offen offset:0  lds
v_mfma_f32_32x32x16_bf16 v[240:255], v[20:23], v[36:39], v[240:255]
v_mfma_f32_32x32x16_bf16 v[224:239], v[20:23], v[32:35], v[224:239]
buffer_load_dwordx4 v13, s[16:19], s45 offen offset:1024  lds
v_mfma_f32_32x32x16_bf16 v[208:223], v[20:23], v[28:31], v[208:223]
v_mfma_f32_32x32x16_bf16 v[192:207], v[20:23], v[24:27], v[192:207]
s_waitcnt lgkmcnt(0)
s_waitcnt vmcnt(6)
s_barrier
v_mfma_f32_32x32x16_bf16 v[128:143], v[40:43], v[48:51], v[128:143]
ds_read_b128 v[16:19], v6 offset:0
ds_read_b128 v[24:27], v10 offset:0
v_mfma_f32_32x32x16_bf16 v[144:159], v[40:43], v[52:55], v[144:159]
ds_read_b128 v[28:31], v10 offset:512
ds_read_b128 v[32:35], v10 offset:1024
v_mfma_f32_32x32x16_bf16 v[160:175], v[40:43], v[56:59], v[160:175]
ds_read_b128 v[36:39], v10 offset:1536
ds_read_b128 v[20:23], v6 offset:4096
v_mfma_f32_32x32x16_bf16 v[176:191], v[40:43], v[60:63], v[176:191]
buffer_load_dwordx4 v12, s[16:19], s46 offen offset:2048  lds
v_mfma_f32_32x32x16_bf16 v[240:255], v[44:47], v[60:63], v[240:255]
v_mfma_f32_32x32x16_bf16 v[224:239], v[44:47], v[56:59], v[224:239]
buffer_load_dwordx4 v13, s[16:19], s47 offen offset:3072  lds
v_mfma_f32_32x32x16_bf16 v[208:223], v[44:47], v[52:55], v[208:223]
v_mfma_f32_32x32x16_bf16 v[192:207], v[44:47], v[48:51], v[192:207]
s_waitcnt lgkmcnt(0)
v_mfma_f32_32x32x16_bf16 v[128:143], v[16:19], v[24:27], v[128:143]
ds_read_b128 v[40:43], v7 offset:0
ds_read_b128 v[48:51], v10 offset:4096
v_mfma_f32_32x32x16_bf16 v[144:159], v[16:19], v[28:31], v[144:159]
ds_read_b128 v[52:55], v10 offset:4608
ds_read_b128 v[56:59], v10 offset:5120
v_mfma_f32_32x32x16_bf16 v[160:175], v[16:19], v[32:35], v[160:175]
ds_read_b128 v[60:63], v10 offset:5632
ds_read_b128 v[44:47], v7 offset:4096
v_mfma_f32_32x32x16_bf16 v[176:191], v[16:19], v[36:39], v[176:191]
s_bfe_u32 s89, s97, 262144
s_lshl_b32 s90, s89, 7
s_add_u32 s16, s86, s90
s_addc_u32 s17, s87, 0
s_sub_u32 s18, s88, s90
s_add_u32 m0, s56, 0
s_nop 0
buffer_load_dwordx4 v12, s[16:19], s40 offen offset:0  lds
v_mfma_f32_32x32x16_bf16 v[240:255], v[20:23], v[36:39], v[240:255]
v_mfma_f32_32x32x16_bf16 v[224:239], v[20:23], v[32:35], v[224:239]
buffer_load_dwordx4 v13, s[16:19], s41 offen offset:1024  lds
v_mfma_f32_32x32x16_bf16 v[208:223], v[20:23], v[28:31], v[208:223]
v_mfma_f32_32x32x16_bf16 v[192:207], v[20:23], v[24:27], v[192:207]
s_waitcnt lgkmcnt(0)
v_mfma_f32_32x32x16_bf16 v[128:143], v[40:43], v[48:51], v[128:143]
ds_read_b128 v[16:19], v8 offset:0
ds_read_b128 v[24:27], v10 offset:8192
v_mfma_f32_32x32x16_bf16 v[144:159], v[40:43], v[52:55], v[144:159]
ds_read_b128 v[28:31], v10 offset:8704
ds_read_b128 v[32:35], v10 offset:9216
v_mfma_f32_32x32x16_bf16 v[160:175], v[40:43], v[56:59], v[160:175]
ds_read_b128 v[36:39], v10 offset:9728
ds_read_b128 v[20:23], v8 offset:4096
v_mfma_f32_32x32x16_bf16 v[176:191], v[40:43], v[60:63], v[176:191]
buffer_load_dwordx4 v12, s[16:19], s42 offen offset:2048  lds
v_mfma_f32_32x32x16_bf16 v[240:255], v[44:47], v[60:63], v[240:255]
v_mfma_f32_32x32x16_bf16 v[224:239], v[44:47], v[56:59], v[224:239]
buffer_load_dwordx4 v13, s[16:19], s43 offen offset:3072  lds
v_mfma_f32_32x32x16_bf16 v[208:223], v[44:47], v[52:55], v[208:223]
v_mfma_f32_32x32x16_bf16 v[192:207], v[44:47], v[48:51], v[192:207]
s_waitcnt lgkmcnt(0)
v_mfma_f32_32x32x16_bf16 v[128:143], v[16:19], v[24:27], v[128:143]
ds_read_b128 v[40:43], v9 offset:0
ds_read_b128 v[48:51], v10 offset:12288
v_mfma_f32_32x32x16_bf16 v[144:159], v[16:19], v[28:31], v[144:159]
ds_read_b128 v[52:55], v10 offset:12800
ds_read_b128 v[56:59], v10 offset:13312
v_mfma_f32_32x32x16_bf16 v[160:175], v[16:19], v[32:35], v[160:175]
ds_read_b128 v[60:63], v10 offset:13824
ds_read_b128 v[44:47], v9 offset:4096
v_mfma_f32_32x32x16_bf16 v[176:191], v[16:19], v[36:39], v[176:191]
s_add_u32 m0, s56, 4096
s_nop 0
buffer_load_dwordx4 v12, s[16:19], s44 offen offset:0  lds
v_mfma_f32_32x32x16_bf16 v[240:255], v[20:23], v[36:39], v[240:255]
v_mfma_f32_32x32x16_bf16 v[224:239], v[20:23], v[32:35], v[224:239]
buffer_load_dwordx4 v13, s[16:19], s45 offen offset:1024  lds
v_mfma_f32_32x32x16_bf16 v[208:223], v[20:23], v[28:31], v[208:223]
v_mfma_f32_32x32x16_bf16 v[192:207], v[20:23], v[24:27], v[192:207]
s_waitcnt lgkmcnt(0)
s_waitcnt vmcnt(6)
s_barrier
v_mfma_f32_32x32x16_bf16 v[128:143], v[40:43], v[48:51], v[128:143]
ds_read_b128 v[16:19], v6 offset:32768
ds_read_b128 v[24:27], v10 offset:16384
v_mfma_f32_32x32x16_bf16 v[144:159], v[40:43], v[52:55], v[144:159]
ds_read_b128 v[28:31], v10 offset:16896
ds_read_b128 v[32:35], v10 offset:17408
v_mfma_f32_32x32x16_bf16 v[160:175], v[40:43], v[56:59], v[160:175]
ds_read_b128 v[36:39], v10 offset:17920
ds_read_b128 v[20:23], v6 offset:36864
v_mfma_f32_32x32x16_bf16 v[176:191], v[40:43], v[60:63], v[176:191]
buffer_load_dwordx4 v12, s[16:19], s46 offen offset:2048  lds
v_mfma_f32_32x32x16_bf16 v[240:255], v[44:47], v[60:63], v[240:255]
v_mfma_f32_32x32x16_bf16 v[224:239], v[44:47], v[56:59], v[224:239]
buffer_load_dwordx4 v13, s[16:19], s47 offen offset:3072  lds
v_mfma_f32_32x32x16_bf16 v[208:223], v[44:47], v[52:55], v[208:223]
v_mfma_f32_32x32x16_bf16 v[192:207], v[44:47], v[48:51], v[192:207]
s_waitcnt lgkmcnt(0)
v_mfma_f32_32x32x16_bf16 v[128:143], v[16:19], v[24:27], v[128:143]
ds_read_b128 v[40:43], v7 offset:32768
ds_read_b128 v[48:51], v10 offset:20480
v_mfma_f32_32x32x16_bf16 v[144:159], v[16:19], v[28:31], v[144:159]
ds_read_b128 v[52:55], v10 offset:20992
ds_read_b128 v[56:59], v10 offset:21504
v_mfma_f32_32x32x16_bf16 v[160:175], v[16:19], v[32:35], v[160:175]
ds_read_b128 v[60:63], v10 offset:22016
ds_read_b128 v[44:47], v7 offset:36864
v_mfma_f32_32x32x16_bf16 v[176:191], v[16:19], v[36:39], v[176:191]
s_bfe_u32 s89, s97, 262148
s_lshl_b32 s90, s89, 7
s_add_u32 s16, s86, s90
s_addc_u32 s17, s87, 0
s_sub_u32 s18, s88, s90
s_add_u32 m0, s56, 32768
s_nop 0
buffer_load_dwordx4 v12, s[16:19], s40 offen offset:0  lds
v_mfma_f32_32x32x16_bf16 v[240:255], v[20:23], v[36:39], v[240:255]
v_mfma_f32_32x32x16_bf16 v[224:239], v[20:23], v[32:35], v[224:239]
buffer_load_dwordx4 v13, s[16:19], s41 offen offset:1024  lds
v_mfma_f32_32x32x16_bf16 v[208:223], v[20:23], v[28:31], v[208:223]
v_mfma_f32_32x32x16_bf16 v[192:207], v[20:23], v[24:27], v[192:207]
s_waitcnt lgkmcnt(0)
v_mfma_f32_32x32x16_bf16 v[128:143], v[40:43], v[48:51], v[128:143]
ds_read_b128 v[16:19], v8 offset:32768
ds_read_b128 v[24:27], v10 offset:24576
v_mfma_f32_32x32x16_bf16 v[144:159], v[40:43], v[52:55], v[144:159]
ds_read_b128 v[28:31], v10 offset:25088
ds_read_b128 v[32:35], v10 offset:25600
v_mfma_f32_32x32x16_bf16 v[160:175], v[40:43], v[56:59], v[160:175]
ds_read_b128 v[36:39], v10 offset:26112
ds_read_b128 v[20:23], v8 offset:36864
v_mfma_f32_32x32x16_bf16 v[176:191], v[40:43], v[60:63], v[176:191]
buffer_load_dwordx4 v12, s[16:19], s42 offen offset:2048  lds
v_mfma_f32_32x32x16_bf16 v[240:255], v[44:47], v[60:63], v[240:255]
v_mfma_f32_32x32x16_bf16 v[224:239], v[44:47], v[56:59], v[224:239]
buffer_load_dwordx4 v13, s[16:19], s43 offen offset:3072  lds
v_mfma_f32_32x32x16_bf16 v[208:223], v[44:47], v[52:55], v[208:223]
v_mfma_f32_32x32x16_bf16 v[192:207], v[44:47], v[48:51], v[192:207]
s_waitcnt lgkmcnt(0)
v_mfma_f32_32x32x16_bf16 v[128:143], v[16:19], v[24:27], v[128:143]
ds_read_b128 v[40:43], v9 offset:32768
ds_read_b128 v[48:51], v10 offset:28672
v_mfma_f32_32x32x16_bf16 v[144:159], v[16:19], v[28:31], v[144:159]
ds_read_b128 v[52:55], v10 offset:29184
ds_read_b128 v[56:59], v10 offset:29696
v_mfma_f32_32x32x16_bf16 v[160:175], v[16:19], v[32:35], v[160:175]
ds_read_b128 v[60:63], v10 offset:30208
ds_read_b128 v[44:47], v9 offset:36864
v_mfma_f32_32x32x16_bf16 v[176:191], v[16:19], v[36:39], v[176:191]
s_add_u32 m0, s56, 36864
s_nop 0
buffer_load_dwordx4 v12, s[16:19], s44 offen offset:0  lds
v_mfma_f32_32x32x16_bf16 v[240:255], v[20:23], v[36:39], v[240:255]
v_mfma_f32_32x32x16_bf16 v[224:239], v[20:23], v[32:35], v[224:239]
buffer_load_dwordx4 v13, s[16:19], s45 offen offset:1024  lds
v_mfma_f32_32x32x16_bf16 v[208:223], v[20:23], v[28:31], v[208:223]
v_mfma_f32_32x32x16_bf16 v[192:207], v[20:23], v[24:27], v[192:207]
s_waitcnt lgkmcnt(0)
s_waitcnt vmcnt(6)
s_barrier
v_mfma_f32_32x32x16_bf16 v[128:143], v[40:43], v[48:51], v[128:143]
ds_read_b128 v[16:19], v2 offset:0
ds_read_b128 v[24:27], v10 offset:0
v_mfma_f32_32x32x16_bf16 v[144:159], v[40:43], v[52:55], v[144:159]
ds_read_b128 v[28:31], v10 offset:512
ds_read_b128 v[32:35], v10 offset:1024
v_mfma_f32_32x32x16_bf16 v[160:175], v[40:43], v[56:59], v[160:175]
ds_read_b128 v[36:39], v10 offset:1536
ds_read_b128 v[20:23], v2 offset:4096
v_mfma_f32_32x32x16_bf16 v[176:191], v[40:43], v[60:63], v[176:191]
buffer_load_dwordx4 v12, s[16:19], s46 offen offset:2048  lds
v_mfma_f32_32x32x16_bf16 v[240:255], v[44:47], v[60:63], v[240:255]
v_mfma_f32_32x32x16_bf16 v[224:239], v[44:47], v[56:59], v[224:239]
buffer_load_dwordx4 v13, s[16:19], s47 offen offset:3072  lds
v_mfma_f32_32x32x16_bf16 v[208:223], v[44:47], v[52:55], v[208:223]
v_mfma_f32_32x32x16_bf16 v[192:207], v[44:47], v[48:51], v[192:207]
s_waitcnt lgkmcnt(0)
v_mfma_f32_32x32x16_bf16 v[128:143], v[16:19], v[24:27], v[128:143]
ds_read_b128 v[40:43], v3 offset:0
ds_read_b128 v[48:51], v10 offset:4096
v_mfma_f32_32x32x16_bf16 v[144:159], v[16:19], v[28:31], v[144:159]
ds_read_b128 v[52:55], v10 offset:4608
ds_read_b128 v[56:59], v10 offset:5120
v_mfma_f32_32x32x16_bf16 v[160:175], v[16:19], v[32:35], v[160:175]
ds_read_b128 v[60:63], v10 offset:5632
ds_read_b128 v[44:47], v3 offset:4096
v_mfma_f32_32x32x16_bf16 v[176:191], v[16:19], v[36:39], v[176:191]
s_bfe_u32 s89, s97, 262152
s_lshl_b32 s90, s89, 7
s_add_u32 s16, s86, s90
s_addc_u32 s17, s87, 0
s_sub_u32 s18, s88, s90
s_add_u32 m0, s56, 65536
s_nop 0
buffer_load_dwordx4 v12, s[16:19], s40 offen offset:0  lds
v_mfma_f32_32x32x16_bf16 v[240:255], v[20:23], v[36:39], v[240:255]
v_mfma_f32_32x32x16_bf16 v[224:239], v[20:23], v[32:35], v[224:239]
buffer_load_dwordx4 v13, s[16:19], s41 offen offset:1024  lds
v_mfma_f32_32x32x16_bf16 v[208:223], v[20:23], v[28:31], v[208:223]
v_mfma_f32_32x32x16_bf16 v[192:207], v[20:23], v[24:27], v[192:207]
s_waitcnt lgkmcnt(0)
v_mfma_f32_32x32x16_bf16 v[128:143], v[40:43], v[48:51], v[128:143]
ds_read_b128 v[16:19], v4 offset:0
ds_read_b128 v[24:27], v10 offset:8192
v_mfma_f32_32x32x16_bf16 v[144:159], v[40:43], v[52:55], v[144:159]
ds_read_b128 v[28:31], v10 offset:8704
ds_read_b128 v[32:35], v10 offset:9216
v_mfma_f32_32x32x16_bf16 v[160:175], v[40:43], v[56:59], v[160:175]
ds_read_b128 v[36:39], v10 offset:9728
ds_read_b128 v[20:23], v4 offset:4096
v_mfma_f32_32x32x16_bf16 v[176:191], v[40:43], v[60:63], v[176:191]
buffer_load_dwordx4 v12, s[16:19], s42 offen offset:2048  lds
v_mfma_f32_32x32x16_bf16 v[240:255], v[44:47], v[60:63], v[240:255]
v_mfma_f32_32x32x16_bf16 v[224:239], v[44:47], v[56:59], v[224:239]
buffer_load_dwordx4 v13, s[16:19], s43 offen offset:3072  lds
v_mfma_f32_32x32x16_bf16 v[208:223], v[44:47], v[52:55], v[208:223]
v_mfma_f32_32x32x16_bf16 v[192:207], v[44:47], v[48:51], v[192:207]
s_waitcnt lgkmcnt(0)
v_mfma_f32_32x32x16_bf16 v[128:143], v[16:19], v[24:27], v[128:143]
ds_read_b128 v[40:43], v5 offset:0
ds_read_b128 v[48:51], v10 offset:12288
v_mfma_f32_32x32x16_bf16 v[144:159], v[16:19], v[28:31], v[144:159]
ds_read_b128 v[52:55], v10 offset:12800
ds_read_b128 v[56:59], v10 offset:13312
v_mfma_f32_32x32x16_bf16 v[160:175], v[16:19], v[32:35], v[160:175]
ds_read_b128 v[60:63], v10 offset:13824
ds_read_b128 v[44:47], v5 offset:4096
v_mfma_f32_32x32x16_bf16 v[176:191], v[16:19], v[36:39], v[176:191]
s_add_u32 m0, s56, 69632
s_nop 0
buffer_load_dwordx4 v12, s[16:19], s44 offen offset:0  lds
v_mfma_f32_32x32x16_bf16 v[240:255], v[20:23], v[36:39], v[240:255]
v_mfma_f32_32x32x16_bf16 v[224:239], v[20:23], v[32:35], v[224:239]
buffer_load_dwordx4 v13, s[16:19], s45 offen offset:1024  lds
v_mfma_f32_32x32x16_bf16 v[208:223], v[20:23], v[28:31], v[208:223]
v_mfma_f32_32x32x16_bf16 v[192:207], v[20:23], v[24:27], v[192:207]
s_waitcnt lgkmcnt(0)
s_waitcnt vmcnt(6)
s_barrier
v_mfma_f32_32x32x16_bf16 v[128:143], v[40:43], v[48:51], v[128:143]
ds_read_b128 v[16:19], v2 offset:32768
ds_read_b128 v[24:27], v10 offset:16384
v_mfma_f32_32x32x16_bf16 v[144:159], v[40:43], v[52:55], v[144:159]
ds_read_b128 v[28:31], v10 offset:16896
ds_read_b128 v[32:35], v10 offset:17408
v_mfma_f32_32x32x16_bf16 v[160:175], v[40:43], v[56:59], v[160:175]
ds_read_b128 v[36:39], v10 offset:17920
ds_read_b128 v[20:23], v2 offset:36864
v_mfma_f32_32x32x16_bf16 v[176:191], v[40:43], v[60:63], v[176:191]
buffer_load_dwordx4 v12, s[16:19], s46 offen offset:2048  lds
v_mfma_f32_32x32x16_bf16 v[240:255], v[44:47], v[60:63], v[240:255]
v_mfma_f32_32x32x16_bf16 v[224:239], v[44:47], v[56:59], v[224:239]
buffer_load_dwordx4 v13, s[16:19], s47 offen offset:3072  lds
v_mfma_f32_32x32x16_bf16 v[208:223], v[44:47], v[52:55], v[208:223]
v_mfma_f32_32x32x16_bf16 v[192:207], v[44:47], v[48:51], v[192:207]
s_waitcnt lgkmcnt(0)
v_mfma_f32_32x32x16_bf16 v[128:143], v[16:19], v[24:27], v[128:143]
ds_read_b128 v[40:43], v3 offset:32768
ds_read_b128 v[48:51], v10 offset:20480
v_mfma_f32_32x32x16_bf16 v[144:159], v[16:19], v[28:31], v[144:159]
ds_read_b128 v[52:55], v10 offset:20992
ds_read_b128 v[56:59], v10 offset:21504
v_mfma_f32_32x32x16_bf16 v[160:175], v[16:19], v[32:35], v[160:175]
ds_read_b128 v[60:63], v10 offset:22016
ds_read_b128 v[44:47], v3 offset:36864
v_mfma_f32_32x32x16_bf16 v[176:191], v[16:19], v[36:39], v[176:191]
s_bfe_u32 s89, s97, 262156
s_lshl_b32 s90, s89, 7
s_add_u32 s16, s86, s90
s_addc_u32 s17, s87, 0
s_sub_u32 s18, s88, s90
s_add_u32 m0, s56, 98304
s_nop 0
buffer_load_dwordx4 v12, s[16:19], s40 offen offset:0  lds
v_mfma_f32_32x32x16_bf16 v[240:255], v[20:23], v[36:39], v[240:255]
v_mfma_f32_32x32x16_bf16 v[224:239], v[20:23], v[32:35], v[224:239]
buffer_load_dwordx4 v13, s[16:19], s41 offen offset:1024  lds
v_mfma_f32_32x32x16_bf16 v[208:223], v[20:23], v[28:31], v[208:223]
v_mfma_f32_32x32x16_bf16 v[192:207], v[20:23], v[24:27], v[192:207]
s_waitcnt lgkmcnt(0)
v_mfma_f32_32x32x16_bf16 v[128:143], v[40:43], v[48:51], v[128:143]
ds_read_b128 v[16:19], v4 offset:32768
ds_read_b128 v[24:27], v10 offset:24576
v_mfma_f32_32x32x16_bf16 v[144:159], v[40:43], v[52:55], v[144:159]
ds_read_b128 v[28:31], v10 offset:25088
ds_read_b128 v[32:35], v10 offset:25600
v_mfma_f32_32x32x16_bf16 v[160:175], v[40:43], v[56:59], v[160:175]
ds_read_b128 v[36:39], v10 offset:26112
ds_read_b128 v[20:23], v4 offset:36864
v_mfma_f32_32x32x16_bf16 v[176:191], v[40:43], v[60:63], v[176:191]
buffer_load_dwordx4 v12, s[16:19], s42 offen offset:2048  lds
v_mfma_f32_32x32x16_bf16 v[240:255], v[44:47], v[60:63], v[240:255]
v_mfma_f32_32x32x16_bf16 v[224:239], v[44:47], v[56:59], v[224:239]
buffer_load_dwordx4 v13, s[16:19], s43 offen offset:3072  lds
v_mfma_f32_32x32x16_bf16 v[208:223], v[44:47], v[52:55], v[208:223]
v_mfma_f32_32x32x16_bf16 v[192:207], v[44:47], v[48:51], v[192:207]
s_waitcnt lgkmcnt(0)
v_mfma_f32_32x32x16_bf16 v[128:143], v[16:19], v[24:27], v[128:143]
ds_read_b128 v[40:43], v5 offset:32768
ds_read_b128 v[48:51], v10 offset:28672
v_mfma_f32_32x32x16_bf16 v[144:159], v[16:19], v[28:31], v[144:159]
ds_read_b128 v[52:55], v10 offset:29184
ds_read_b128 v[56:59], v10 offset:29696
v_mfma_f32_32x32x16_bf16 v[160:175], v[16:19], v[32:35], v[160:175]
ds_read_b128 v[60:63], v10 offset:30208
ds_read_b128 v[44:47], v5 offset:36864
v_mfma_f32_32x32x16_bf16 v[176:191], v[16:19], v[36:39], v[176:191]
s_add_u32 m0, s56, 102400
s_nop 0
buffer_load_dwordx4 v12, s[16:19], s44 offen offset:0  lds
v_mfma_f32_32x32x16_bf16 v[240:255], v[20:23], v[36:39], v[240:255]
v_mfma_f32_32x32x16_bf16 v[224:239], v[20:23], v[32:35], v[224:239]
buffer_load_dwordx4 v13, s[16:19], s45 offen offset:1024  lds
v_mfma_f32_32x32x16_bf16 v[208:223], v[20:23], v[28:31], v[208:223]
v_mfma_f32_32x32x16_bf16 v[192:207], v[20:23], v[24:27], v[192:207]
s_waitcnt lgkmcnt(0)
s_waitcnt vmcnt(6)
s_barrier
v_mfma_f32_32x32x16_bf16 v[128:143], v[40:43], v[48:51], v[128:143]
ds_read_b128 v[16:19], v6 offset:0
ds_read_b128 v[24:27], v10 offset:0
v_mfma_f32_32x32x16_bf16 v[144:159], v[40:43], v[52:55], v[144:159]
ds_read_b128 v[28:31], v10 offset:512
ds_read_b128 v[32:35], v10 offset:1024
v_mfma_f32_32x32x16_bf16 v[160:175], v[40:43], v[56:59], v[160:175]
ds_read_b128 v[36:39], v10 offset:1536
ds_read_b128 v[20:23], v6 offset:4096
v_mfma_f32_32x32x16_bf16 v[176:191], v[40:43], v[60:63], v[176:191]
buffer_load_dwordx4 v12, s[16:19], s46 offen offset:2048  lds
v_mfma_f32_32x32x16_bf16 v[240:255], v[44:47], v[60:63], v[240:255]
v_mfma_f32_32x32x16_bf16 v[224:239], v[44:47], v[56:59], v[224:239]
buffer_load_dwordx4 v13, s[16:19], s47 offen offset:3072  lds
v_mfma_f32_32x32x16_bf16 v[208:223], v[44:47], v[52:55], v[208:223]
v_mfma_f32_32x32x16_bf16 v[192:207], v[44:47], v[48:51], v[192:207]
s_waitcnt lgkmcnt(0)
v_mfma_f32_32x32x16_bf16 v[128:143], v[16:19], v[24:27], v[128:143]
ds_read_b128 v[40:43], v7 offset:0
ds_read_b128 v[48:51], v10 offset:4096
v_mfma_f32_32x32x16_bf16 v[144:159], v[16:19], v[28:31], v[144:159]
ds_read_b128 v[52:55], v10 offset:4608
ds_read_b128 v[56:59], v10 offset:5120
v_mfma_f32_32x32x16_bf16 v[160:175], v[16:19], v[32:35], v[160:175]
ds_read_b128 v[60:63], v10 offset:5632
ds_read_b128 v[44:47], v7 offset:4096
v_mfma_f32_32x32x16_bf16 v[176:191], v[16:19], v[36:39], v[176:191]
s_bfe_u32 s89, s97, 262160
s_lshl_b32 s90, s89, 7
s_add_u32 s16, s86, s90
s_addc_u32 s17, s87, 0
s_sub_u32 s18, s88, s90
s_add_u32 m0, s56, 0
s_nop 0
buffer_load_dwordx4 v12, s[16:19], s40 offen offset:0  lds
v_mfma_f32_32x32x16_bf16 v[240:255], v[20:23], v[36:39], v[240:255]
v_mfma_f32_32x32x16_bf16 v[224:239], v[20:23], v[32:35], v[224:239]
buffer_load_dwordx4 v13, s[16:19], s41 offen offset:1024  lds
v_mfma_f32_32x32x16_bf16 v[208:223], v[20:23], v[28:31], v[208:223]
v_mfma_f32_32x32x16_bf16 v[192:207], v[20:23], v[24:27], v[192:207]
s_waitcnt lgkmcnt(0)
v_mfma_f32_32x32x16_bf16 v[128:143], v[40:43], v[48:51], v[128:143]
ds_read_b128 v[16:19], v8 offset:0
ds_read_b128 v[24:27], v10 offset:8192
v_mfma_f32_32x32x16_bf16 v[144:159], v[40:43], v[52:55], v[144:159]
ds_read_b128 v[28:31], v10 offset:8704
ds_read_b128 v[32:35], v10 offset:9216
v_mfma_f32_32x32x16_bf16 v[160:175], v[40:43], v[56:59], v[160:175]
ds_read_b128 v[36:39], v10 offset:9728
ds_read_b128 v[20:23], v8 offset:4096
v_mfma_f32_32x32x16_bf16 v[176:191], v[40:43], v[60:63], v[176:191]
buffer_load_dwordx4 v12, s[16:19], s42 offen offset:2048  lds
v_mfma_f32_32x32x16_bf16 v[240:255], v[44:47], v[60:63], v[240:255]
v_mfma_f32_32x32x16_bf16 v[224:239], v[44:47], v[56:59], v[224:239]
buffer_load_dwordx4 v13, s[16:19], s43 offen offset:3072  lds
v_mfma_f32_32x32x16_bf16 v[208:223], v[44:47], v[52:55], v[208:223]
v_mfma_f32_32x32x16_bf16 v[192:207], v[44:47], v[48:51], v[192:207]
s_waitcnt lgkmcnt(0)
v_mfma_f32_32x32x16_bf16 v[128:143], v[16:19], v[24:27], v[128:143]
ds_read_b128 v[40:43], v9 offset:0
ds_read_b128 v[48:51], v10 offset:12288
v_mfma_f32_32x32x16_bf16 v[144:159], v[16:19], v[28:31], v[144:159]
ds_read_b128 v[52:55], v10 offset:12800
ds_read_b128 v[56:59], v10 offset:13312
v_mfma_f32_32x32x16_bf16 v[160:175], v[16:19], v[32:35], v[160:175]
ds_read_b128 v[60:63], v10 offset:13824
ds_read_b128 v[44:47], v9 offset:4096
v_mfma_f32_32x32x16_bf16 v[176:191], v[16:19], v[36:39], v[176:191]
s_add_u32 m0, s56, 4096
s_nop 0
buffer_load_dwordx4 v12, s[16:19], s44 offen offset:0  lds
v_mfma_f32_32x32x16_bf16 v[240:255], v[20:23], v[36:39], v[240:255]
v_mfma_f32_32x32x16_bf16 v[224:239], v[20:23], v[32:35], v[224:239]
buffer_load_dwordx4 v13, s[16:19], s45 offen offset:1024  lds
v_mfma_f32_32x32x16_bf16 v[208:223], v[20:23], v[28:31], v[208:223]
v_mfma_f32_32x32x16_bf16 v[192:207], v[20:23], v[24:27], v[192:207]
s_waitcnt lgkmcnt(0)
s_waitcnt vmcnt(6)
s_barrier
v_mfma_f32_32x32x16_bf16 v[128:143], v[40:43], v[48:51], v[128:143]
ds_read_b128 v[16:19], v6 offset:32768
ds_read_b128 v[24:27], v10 offset:16384
v_mfma_f32_32x32x16_bf16 v[144:159], v[40:43], v[52:55], v[144:159]
ds_read_b128 v[28:31], v10 offset:16896
ds_read_b128 v[32:35], v10 offset:17408
v_mfma_f32_32x32x16_bf16 v[160:175], v[40:43], v[56:59], v[160:175]
ds_read_b128 v[36:39], v10 offset:17920
ds_read_b128 v[20:23], v6 offset:36864
v_mfma_f32_32x32x16_bf16 v[176:191], v[40:43], v[60:63], v[176:191]
buffer_load_dwordx4 v12, s[16:19], s46 offen offset:2048  lds
v_mfma_f32_32x32x16_bf16 v[240:255], v[44:47], v[60:63], v[240:255]
v_mfma_f32_32x32x16_bf16 v[224:239], v[44:47], v[56:59], v[224:239]
buffer_load_dwordx4 v13, s[16:19], s47 offen offset:3072  lds
v_mfma_f32_32x32x16_bf16 v[208:223], v[44:47], v[52:55], v[208:223]
v_mfma_f32_32x32x16_bf16 v[192:207], v[44:47], v[48:51], v[192:207]
s_waitcnt lgkmcnt(0)
v_mfma_f32_32x32x16_bf16 v[128:143], v[16:19], v[24:27], v[128:143]
ds_read_b128 v[40:43], v7 offset:32768
ds_read_b128 v[48:51], v10 offset:20480
v_mfma_f32_32x32x16_bf16 v[144:159], v[16:19], v[28:31], v[144:159]
ds_read_b128 v[52:55], v10 offset:20992
ds_read_b128 v[56:59], v10 offset:21504
v_mfma_f32_32x32x16_bf16 v[160:175], v[16:19], v[32:35], v[160:175]
ds_read_b128 v[60:63], v10 offset:22016
ds_read_b128 v[44:47], v7 offset:36864
v_mfma_f32_32x32x16_bf16 v[176:191], v[16:19], v[36:39], v[176:191]
s_bfe_u32 s89, s97, 262164
s_lshl_b32 s90, s89, 7
s_add_u32 s16, s86, s90
s_addc_u32 s17, s87, 0
s_sub_u32 s18, s88, s90
s_add_u32 m0, s56, 32768
s_nop 0
buffer_load_dwordx4 v12, s[16:19], s40 offen offset:0  lds
v_mfma_f32_32x32x16_bf16 v[240:255], v[20:23], v[36:39], v[240:255]
v_mfma_f32_32x32x16_bf16 v[224:239], v[20:23], v[32:35], v[224:239]
buffer_load_dwordx4 v13, s[16:19], s41 offen offset:1024  lds
v_mfma_f32_32x32x16_bf16 v[208:223], v[20:23], v[28:31], v[208:223]
v_mfma_f32_32x32x16_bf16 v[192:207], v[20:23], v[24:27], v[192:207]
s_waitcnt lgkmcnt(0)
v_mfma_f32_32x32x16_bf16 v[128:143], v[40:43], v[48:51], v[128:143]
ds_read_b128 v[16:19], v8 offset:32768
ds_read_b128 v[24:27], v10 offset:24576
v_mfma_f32_32x32x16_bf16 v[144:159], v[40:43], v[52:55], v[144:159]
ds_read_b128 v[28:31], v10 offset:25088
ds_read_b128 v[32:35], v10 offset:25600
v_mfma_f32_32x32x16_bf16 v[160:175], v[40:43], v[56:59], v[160:175]
ds_read_b128 v[36:39], v10 offset:26112
ds_read_b128 v[20:23], v8 offset:36864
v_mfma_f32_32x32x16_bf16 v[176:191], v[40:43], v[60:63], v[176:191]
buffer_load_dwordx4 v12, s[16:19], s42 offen offset:2048  lds
v_mfma_f32_32x32x16_bf16 v[240:255], v[44:47], v[60:63], v[240:255]
v_mfma_f32_32x32x16_bf16 v[224:239], v[44:47], v[56:59], v[224:239]
buffer_load_dwordx4 v13, s[16:19], s43 offen offset:3072  lds
v_mfma_f32_32x32x16_bf16 v[208:223], v[44:47], v[52:55], v[208:223]
v_mfma_f32_32x32x16_bf16 v[192:207], v[44:47], v[48:51], v[192:207]
s_waitcnt lgkmcnt(0)
v_mfma_f32_32x32x16_bf16 v[128:143], v[16:19], v[24:27], v[128:143]
ds_read_b128 v[40:43], v9 offset:32768
ds_read_b128 v[48:51], v10 offset:28672
v_mfma_f32_32x32x16_bf16 v[144:159], v[16:19], v[28:31], v[144:159]
ds_read_b128 v[52:55], v10 offset:29184
ds_read_b128 v[56:59], v10 offset:29696
v_mfma_f32_32x32x16_bf16 v[160:175], v[16:19], v[32:35], v[160:175]
ds_read_b128 v[60:63], v10 offset:30208
ds_read_b128 v[44:47], v9 offset:36864
v_mfma_f32_32x32x16_bf16 v[176:191], v[16:19], v[36:39], v[176:191]
s_add_u32 m0, s56, 36864
s_nop 0
buffer_load_dwordx4 v12, s[16:19], s44 offen offset:0  lds
v_mfma_f32_32x32x16_bf16 v[240:255], v[20:23], v[36:39], v[240:255]
v_mfma_f32_32x32x16_bf16 v[224:239], v[20:23], v[32:35], v[224:239]
buffer_load_dwordx4 v13, s[16:19], s45 offen offset:1024  lds
v_mfma_f32_32x32x16_bf16 v[208:223], v[20:23], v[28:31], v[208:223]
v_mfma_f32_32x32x16_bf16 v[192:207], v[20:23], v[24:27], v[192:207]
s_waitcnt lgkmcnt(0)
s_waitcnt vmcnt(6)
s_barrier
v_mfma_f32_32x32x16_bf16 v[128:143], v[40:43], v[48:51], v[128:143]
ds_read_b128 v[16:19], v2 offset:0
ds_read_b128 v[24:27], v10 offset:0
v_mfma_f32_32x32x16_bf16 v[144:159], v[40:43], v[52:55], v[144:159]
ds_read_b128 v[28:31], v10 offset:512
ds_read_b128 v[32:35], v10 offset:1024
v_mfma_f32_32x32x16_bf16 v[160:175], v[40:43], v[56:59], v[160:175]
ds_read_b128 v[36:39], v10 offset:1536
ds_read_b128 v[20:23], v2 offset:4096
v_mfma_f32_32x32x16_bf16 v[176:191], v[40:43], v[60:63], v[176:191]
buffer_load_dwordx4 v12, s[16:19], s46 offen offset:2048  lds
v_mfma_f32_32x32x16_bf16 v[240:255], v[44:47], v[60:63], v[240:255]
v_mfma_f32_32x32x16_bf16 v[224:239], v[44:47], v[56:59], v[224:239]
buffer_load_dwordx4 v13, s[16:19], s47 offen offset:3072  lds
v_mfma_f32_32x32x16_bf16 v[208:223], v[44:47], v[52:55], v[208:223]
v_mfma_f32_32x32x16_bf16 v[192:207], v[44:47], v[48:51], v[192:207]
s_waitcnt lgkmcnt(0)
v_mfma_f32_32x32x16_bf16 v[128:143], v[16:19], v[24:27], v[128:143]
ds_read_b128 v[40:43], v3 offset:0
ds_read_b128 v[48:51], v10 offset:4096
v_mfma_f32_32x32x16_bf16 v[144:159], v[16:19], v[28:31], v[144:159]
ds_read_b128 v[52:55], v10 offset:4608
ds_read_b128 v[56:59], v10 offset:5120
v_mfma_f32_32x32x16_bf16 v[160:175], v[16:19], v[32:35], v[160:175]
ds_read_b128 v[60:63], v10 offset:5632
ds_read_b128 v[44:47], v3 offset:4096
v_mfma_f32_32x32x16_bf16 v[176:191], v[16:19], v[36:39], v[176:191]
s_bfe_u32 s89, s97, 262168
s_lshl_b32 s90, s89, 7
s_add_u32 s16, s86, s90
s_addc_u32 s17, s87, 0
s_sub_u32 s18, s88, s90
s_add_u32 m0, s56, 65536
s_nop 0
buffer_load_dwordx4 v12, s[16:19], s40 offen offset:0  lds
v_mfma_f32_32x32x16_bf16 v[240:255], v[20:23], v[36:39], v[240:255]
v_mfma_f32_32x32x16_bf16 v[224:239], v[20:23], v[32:35], v[224:239]
buffer_load_dwordx4 v13, s[16:19], s41 offen offset:1024  lds
v_mfma_f32_32x32x16_bf16 v[208:223], v[20:23], v[28:31], v[208:223]
v_mfma_f32_32x32x16_bf16 v[192:207], v[20:23], v[24:27], v[192:207]
s_waitcnt lgkmcnt(0)
v_mfma_f32_32x32x16_bf16 v[128:143], v[40:43], v[48:51], v[128:143]
ds_read_b128 v[16:19], v4 offset:0
ds_read_b128 v[24:27], v10 offset:8192
v_mfma_f32_32x32x16_bf16 v[144:159], v[40:43], v[52:55], v[144:159]
ds_read_b128 v[28:31], v10 offset:8704
ds_read_b128 v[32:35], v10 offset:9216
v_mfma_f32_32x32x16_bf16 v[160:175], v[40:43], v[56:59], v[160:175]
ds_read_b128 v[36:39], v10 offset:9728
ds_read_b128 v[20:23], v4 offset:4096
v_mfma_f32_32x32x16_bf16 v[176:191], v[40:43], v[60:63], v[176:191]
buffer_load_dwordx4 v12, s[16:19], s42 offen offset:2048  lds
v_mfma_f32_32x32x16_bf16 v[240:255], v[44:47], v[60:63], v[240:255]
v_mfma_f32_32x32x16_bf16 v[224:239], v[44:47], v[56:59], v[224:239]
buffer_load_dwordx4 v13, s[16:19], s43 offen offset:3072  lds
v_mfma_f32_32x32x16_bf16 v[208:223], v[44:47], v[52:55], v[208:223]
v_mfma_f32_32x32x16_bf16 v[192:207], v[44:47], v[48:51], v[192:207]
s_waitcnt lgkmcnt(0)
v_mfma_f32_32x32x16_bf16 v[128:143], v[16:19], v[24:27], v[128:143]
ds_read_b128 v[40:43], v5 offset:0
ds_read_b128 v[48:51], v10 offset:12288
v_mfma_f32_32x32x16_bf16 v[144:159], v[16:19], v[28:31], v[144:159]
ds_read_b128 v[52:55], v10 offset:12800
ds_read_b128 v[56:59], v10 offset:13312
v_mfma_f32_32x32x16_bf16 v[160:175], v[16:19], v[32:35], v[160:175]
ds_read_b128 v[60:63], v10 offset:13824
ds_read_b128 v[44:47], v5 offset:4096
v_mfma_f32_32x32x16_bf16 v[176:191], v[16:19], v[36:39], v[176:191]
s_add_u32 m0, s56, 69632
s_nop 0
buffer_load_dwordx4 v12, s[16:19], s44 offen offset:0  lds
v_mfma_f32_32x32x16_bf16 v[240:255], v[20:23], v[36:39], v[240:255]
v_mfma_f32_32x32x16_bf16 v[224:239], v[20:23], v[32:35], v[224:239]
buffer_load_dwordx4 v13, s[16:19], s45 offen offset:1024  lds
v_mfma_f32_32x32x16_bf16 v[208:223], v[20:23], v[28:31], v[208:223]
v_mfma_f32_32x32x16_bf16 v[192:207], v[20:23], v[24:27], v[192:207]
s_waitcnt lgkmcnt(0)
s_waitcnt vmcnt(6)
s_barrier
v_mfma_f32_32x32x16_bf16 v[128:143], v[40:43], v[48:51], v[128:143]
ds_read_b128 v[16:19], v2 offset:32768
ds_read_b128 v[24:27], v10 offset:16384
v_mfma_f32_32x32x16_bf16 v[144:159], v[40:43], v[52:55], v[144:159]
ds_read_b128 v[28:31], v10 offset:16896
ds_read_b128 v[32:35], v10 offset:17408
v_mfma_f32_32x32x16_bf16 v[160:175], v[40:43], v[56:59], v[160:175]
ds_read_b128 v[36:39], v10 offset:17920
ds_read_b128 v[20:23], v2 offset:36864
v_mfma_f32_32x32x16_bf16 v[176:191], v[40:43], v[60:63], v[176:191]
buffer_load_dwordx4 v12, s[16:19], s46 offen offset:2048  lds
v_mfma_f32_32x32x16_bf16 v[240:255], v[44:47], v[60:63], v[240:255]
v_mfma_f32_32x32x16_bf16 v[224:239], v[44:47], v[56:59], v[224:239]
buffer_load_dwordx4 v13, s[16:19], s47 offen offset:3072  lds
v_mfma_f32_32x32x16_bf16 v[208:223], v[44:47], v[52:55], v[208:223]
v_mfma_f32_32x32x16_bf16 v[192:207], v[44:47], v[48:51], v[192:207]
s_waitcnt lgkmcnt(0)
v_mfma_f32_32x32x16_bf16 v[128:143], v[16:19], v[24:27], v[128:143]
ds_read_b128 v[40:43], v3 offset:32768
ds_read_b128 v[48:51], v10 offset:20480
v_mfma_f32_32x32x16_bf16 v[144:159], v[16:19], v[28:31], v[144:159]
ds_read_b128 v[52:55], v10 offset:20992
ds_read_b128 v[56:59], v10 offset:21504
v_mfma_f32_32x32x16_bf16 v[160:175], v[16:19], v[32:35], v[160:175]
ds_read_b128 v[60:63], v10 offset:22016
ds_read_b128 v[44:47], v3 offset:36864
v_mfma_f32_32x32x16_bf16 v[176:191], v[16:19], v[36:39], v[176:191]
s_bfe_u32 s89, s97, 262172
s_lshl_b32 s90, s89, 7
s_add_u32 s16, s86, s90
s_addc_u32 s17, s87, 0
s_sub_u32 s18, s88, s90
s_add_u32 m0, s56, 98304
s_nop 0
buffer_load_dwordx4 v12, s[16:19], s40 offen offset:0  lds
v_mfma_f32_32x32x16_bf16 v[240:255], v[20:23], v[36:39], v[240:255]
v_mfma_f32_32x32x16_bf16 v[224:239], v[20:23], v[32:35], v[224:239]
buffer_load_dwordx4 v13, s[16:19], s41 offen offset:1024  lds
v_mfma_f32_32x32x16_bf16 v[208:223], v[20:23], v[28:31], v[208:223]
v_mfma_f32_32x32x16_bf16 v[192:207], v[20:23], v[24:27], v[192:207]
s_waitcnt lgkmcnt(0)
v_mfma_f32_32x32x16_bf16 v[128:143], v[40:43], v[48:51], v[128:143]
ds_read_b128 v[16:19], v4 offset:32768
ds_read_b128 v[24:27], v10 offset:24576
v_mfma_f32_32x32x16_bf16 v[144:159], v[40:43], v[52:55], v[144:159]
ds_read_b128 v[28:31], v10 offset:25088
ds_read_b128 v[32:35], v10 offset:25600
v_mfma_f32_32x32x16_bf16 v[160:175], v[40:43], v[56:59], v[160:175]
ds_read_b128 v[36:39], v10 offset:26112
ds_read_b128 v[20:23], v4 offset:36864
v_mfma_f32_32x32x16_bf16 v[176:191], v[40:43], v[60:63], v[176:191]
buffer_load_dwordx4 v12, s[16:19], s42 offen offset:2048  lds
v_mfma_f32_32x32x16_bf16 v[240:255], v[44:47], v[60:63], v[240:255]
v_mfma_f32_32x32x16_bf16 v[224:239], v[44:47], v[56:59], v[224:239]
buffer_load_dwordx4 v13, s[16:19], s43 offen offset:3072  lds
v_mfma_f32_32x32x16_bf16 v[208:223], v[44:47], v[52:55], v[208:223]
v_mfma_f32_32x32x16_bf16 v[192:207], v[44:47], v[48:51], v[192:207]
s_waitcnt lgkmcnt(0)
v_mfma_f32_32x32x16_bf16 v[128:143], v[16:19], v[24:27], v[128:143]
ds_read_b128 v[40:43], v5 offset:32768
ds_read_b128 v[48:51], v10 offset:28672
v_mfma_f32_32x32x16_bf16 v[144:159], v[16:19], v[28:31], v[144:159]
ds_read_b128 v[52:55], v10 offset:29184
ds_read_b128 v[56:59], v10 offset:29696
v_mfma_f32_32x32x16_bf16 v[160:175], v[16:19], v[32:35], v[160:175]
ds_read_b128 v[60:63], v10 offset:30208
ds_read_b128 v[44:47], v5 offset:36864
v_mfma_f32_32x32x16_bf16 v[176:191], v[16:19], v[36:39], v[176:191]
s_add_u32 m0, s56, 102400
s_nop 0
buffer_load_dwordx4 v12, s[16:19], s44 offen offset:0  lds
v_mfma_f32_32x32x16_bf16 v[240:255], v[20:23], v[36:39], v[240:255]
v_mfma_f32_32x32x16_bf16 v[224:239], v[20:23], v[32:35], v[224:239]
buffer_load_dwordx4 v13, s[16:19], s45 offen offset:1024  lds
v_mfma_f32_32x32x16_bf16 v[208:223], v[20:23], v[28:31], v[208:223]
v_mfma_f32_32x32x16_bf16 v[192:207], v[20:23], v[24:27], v[192:207]
s_waitcnt lgkmcnt(0)
s_waitcnt vmcnt(6)
s_barrier
v_mfma_f32_32x32x16_bf16 v[128:143], v[40:43], v[48:51], v[128:143]
ds_read_b128 v[16:19], v6 offset:0
ds_read_b128 v[24:27], v10 offset:0
v_mfma_f32_32x32x16_bf16 v[144:159], v[40:43], v[52:55], v[144:159]
ds_read_b128 v[28:31], v10 offset:512
ds_read_b128 v[32:35], v10 offset:1024
v_mfma_f32_32x32x16_bf16 v[160:175], v[40:43], v[56:59], v[160:175]
ds_read_b128 v[36:39], v10 offset:1536
ds_read_b128 v[20:23], v6 offset:4096
v_mfma_f32_32x32x16_bf16 v[176:191], v[40:43], v[60:63], v[176:191]
buffer_load_dwordx4 v12, s[16:19], s46 offen offset:2048  lds
v_mfma_f32_32x32x16_bf16 v[240:255], v[44:47], v[60:63], v[240:255]
v_mfma_f32_32x32x16_bf16 v[224:239], v[44:47], v[56:59], v[224:239]
buffer_load_dwordx4 v13, s[16:19], s47 offen offset:3072  lds
v_mfma_f32_32x32x16_bf16 v[208:223], v[44:47], v[52:55], v[208:223]
v_mfma_f32_32x32x16_bf16 v[192:207], v[44:47], v[48:51], v[192:207]
s_waitcnt lgkmcnt(0)
v_mfma_f32_32x32x16_bf16 v[128:143], v[16:19], v[24:27], v[128:143]
ds_read_b128 v[40:43], v7 offset:0
ds_read_b128 v[48:51], v10 offset:4096
v_mfma_f32_32x32x16_bf16 v[144:159], v[16:19], v[28:31], v[144:159]
ds_read_b128 v[52:55], v10 offset:4608
ds_read_b128 v[56:59], v10 offset:5120
v_mfma_f32_32x32x16_bf16 v[160:175], v[16:19], v[32:35], v[160:175]
ds_read_b128 v[60:63], v10 offset:5632
ds_read_b128 v[44:47], v7 offset:4096
v_mfma_f32_32x32x16_bf16 v[176:191], v[16:19], v[36:39], v[176:191]
v_mfma_f32_32x32x16_bf16 v[240:255], v[20:23], v[36:39], v[240:255]
v_mfma_f32_32x32x16_bf16 v[224:239], v[20:23], v[32:35], v[224:239]
v_mfma_f32_32x32x16_bf16 v[208:223], v[20:23], v[28:31], v[208:223]
v_mfma_f32_32x32x16_bf16 v[192:207], v[20:23], v[24:27], v[192:207]
s_waitcnt lgkmcnt(0)
v_mfma_f32_32x32x16_bf16 v[128:143], v[40:43], v[48:51], v[128:143]
ds_read_b128 v[16:19], v8 offset:0
ds_read_b128 v[24:27], v10 offset:8192
v_mfma_f32_32x32x16_bf16 v[144:159], v[40:43], v[52:55], v[144:159]
ds_read_b128 v[28:31], v10 offset:8704
ds_read_b128 v[32:35], v10 offset:9216
v_mfma_f32_32x32x16_bf16 v[160:175], v[40:43], v[56:59], v[160:175]
ds_read_b128 v[36:39], v10 offset:9728
ds_read_b128 v[20:23], v8 offset:4096
v_mfma_f32_32x32x16_bf16 v[176:191], v[40:43], v[60:63], v[176:191]
v_mfma_f32_32x32x16_bf16 v[240:255], v[44:47], v[60:63], v[240:255]
v_mfma_f32_32x32x16_bf16 v[224:239], v[44:47], v[56:59], v[224:239]
v_mfma_f32_32x32x16_bf16 v[208:223], v[44:47], v[52:55], v[208:223]
v_mfma_f32_32x32x16_bf16 v[192:207], v[44:47], v[48:51], v[192:207]
s_waitcnt lgkmcnt(0)
v_mfma_f32_32x32x16_bf16 v[128:143], v[16:19], v[24:27], v[128:143]
ds_read_b128 v[64:67], v9 offset:0
ds_read_b128 v[72:75], v10 offset:12288
v_mfma_f32_32x32x16_bf16 v[144:159], v[16:19], v[28:31], v[144:159]
ds_read_b128 v[76:79], v10 offset:12800
ds_read_b128 v[80:83], v10 offset:13312
v_mfma_f32_32x32x16_bf16 v[160:175], v[16:19], v[32:35], v[160:175]
ds_read_b128 v[84:87], v10 offset:13824
ds_read_b128 v[68:71], v9 offset:4096
v_mfma_f32_32x32x16_bf16 v[176:191], v[16:19], v[36:39], v[176:191]
v_mfma_f32_32x32x16_bf16 v[240:255], v[20:23], v[36:39], v[240:255]
v_mfma_f32_32x32x16_bf16 v[224:239], v[20:23], v[32:35], v[224:239]
v_mfma_f32_32x32x16_bf16 v[208:223], v[20:23], v[28:31], v[208:223]
v_mfma_f32_32x32x16_bf16 v[192:207], v[20:23], v[24:27], v[192:207]
s_waitcnt lgkmcnt(0)
s_waitcnt vmcnt(0)
s_barrier
v_mfma_f32_32x32x16_bf16 v[128:143], v[64:67], v[72:75], v[128:143]
ds_read_b128 v[16:19], v6 offset:32768
ds_read_b128 v[24:27], v10 offset:16384
v_mfma_f32_32x32x16_bf16 v[144:159], v[64:67], v[76:79], v[144:159]
ds_read_b128 v[28:31], v10 offset:16896
ds_read_b128 v[32:35], v10 offset:17408
v_mfma_f32_32x32x16_bf16 v[160:175], v[64:67], v[80:83], v[160:175]
ds_read_b128 v[36:39], v10 offset:17920
ds_read_b128 v[20:23], v6 offset:36864
v_mfma_f32_32x32x16_bf16 v[176:191], v[64:67], v[84:87], v[176:191]
v_mfma_f32_32x32x16_bf16 v[240:255], v[68:71], v[84:87], v[240:255]
v_mfma_f32_32x32x16_bf16 v[224:239], v[68:71], v[80:83], v[224:239]
v_mfma_f32_32x32x16_bf16 v[208:223], v[68:71], v[76:79], v[208:223]
v_mfma_f32_32x32x16_bf16 v[192:207], v[68:71], v[72:75], v[192:207]
s_add_u32 s24, s52, 229376
s_addc_u32 s25, s53, 0
s_sub_u32 s26, s54, 229376
s_mov_b32 s27, 0x20000
ds_read_b128 v[40:43], v7 offset:32768
ds_read_b128 v[48:51], v10 offset:20480
ds_read_b128 v[52:55], v10 offset:20992
ds_read_b128 v[56:59], v10 offset:21504
ds_read_b128 v[60:63], v10 offset:22016
ds_read_b128 v[44:47], v7 offset:36864
s_waitcnt lgkmcnt(6)
v_mfma_f32_32x32x16_bf16 v[128:143], v[16:19], v[24:27], v[128:143]
ds_read_b128 v[64:67], v8 offset:32768
ds_read_b128 v[72:75], v10 offset:24576
v_mfma_f32_32x32x16_bf16 v[144:159], v[16:19], v[28:31], v[144:159]
ds_read_b128 v[76:79], v10 offset:25088
ds_read_b128 v[80:83], v10 offset:25600
v_mfma_f32_32x32x16_bf16 v[160:175], v[16:19], v[32:35], v[160:175]
ds_read_b128 v[84:87], v10 offset:26112
ds_read_b128 v[68:71], v8 offset:36864
v_mfma_f32_32x32x16_bf16 v[176:191], v[16:19], v[36:39], v[176:191]
s_waitcnt lgkmcnt(6)
v_mfma_f32_32x32x16_bf16 v[128:143], v[40:43], v[48:51], v[128:143]
ds_read_b128 v[88:91], v9 offset:32768
ds_read_b128 v[96:99], v10 offset:28672
v_mfma_f32_32x32x16_bf16 v[144:159], v[40:43], v[52:55], v[144:159]
ds_read_b128 v[100:103], v10 offset:29184
ds_read_b128 v[104:107], v10 offset:29696
v_mfma_f32_32x32x16_bf16 v[160:175], v[40:43], v[56:59], v[160:175]
ds_read_b128 v[108:111], v10 offset:30208
ds_read_b128 v[92:95], v9 offset:36864
v_mfma_f32_32x32x16_bf16 v[176:191], v[40:43], v[60:63], v[176:191]
s_waitcnt lgkmcnt(6)
v_mfma_f32_32x32x16_bf16 v[128:143], v[64:67], v[72:75], v[128:143]
v_mfma_f32_32x32x16_bf16 v[144:159], v[64:67], v[76:79], v[144:159]
v_mfma_f32_32x32x16_bf16 v[160:175], v[64:67], v[80:83], v[160:175]
v_mfma_f32_32x32x16_bf16 v[176:191], v[64:67], v[84:87], v[176:191]
s_waitcnt lgkmcnt(0)
v_mfma_f32_32x32x16_bf16 v[128:143], v[88:91], v[96:99], v[128:143]
v_mfma_f32_32x32x16_bf16 v[144:159], v[88:91], v[100:103], v[144:159]
v_mfma_f32_32x32x16_bf16 v[160:175], v[88:91], v[104:107], v[160:175]
v_mfma_f32_32x32x16_bf16 v[176:191], v[88:91], v[108:111], v[176:191]
v_mfma_f32_32x32x16_bf16 v[192:207], v[20:23], v[24:27], v[192:207]
v_mfma_f32_32x32x16_bf16 v[208:223], v[20:23], v[28:31], v[208:223]
v_mfma_f32_32x32x16_bf16 v[224:239], v[20:23], v[32:35], v[224:239]
v_mfma_f32_32x32x16_bf16 v[240:255], v[20:23], v[36:39], v[240:255]
s_nop 7
v_mfma_f32_32x32x16_bf16 v[192:207], v[44:47], v[48:51], v[192:207]
v_cvt_pk_bf16_f32 v112, v128, v144
v_cvt_pk_bf16_f32 v113, v160, v176
v_cvt_pk_bf16_f32 v114, v129, v145
v_cvt_pk_bf16_f32 v115, v161, v177
v_cvt_pk_bf16_f32 v116, v130, v146
v_mfma_f32_32x32x16_bf16 v[208:223], v[44:47], v[52:55], v[208:223]
v_cvt_pk_bf16_f32 v117, v162, v178
v_cvt_pk_bf16_f32 v118, v131, v147
v_cvt_pk_bf16_f32 v119, v163, v179
v_permlane16_swap_b32 v112, v114
v_permlane16_swap_b32 v113, v115
v_mfma_f32_32x32x16_bf16 v[224:239], v[44:47], v[56:59], v[224:239]
buffer_store_dwordx4 v[112:115], v11, s[52:55], s32 offen sc1
v_cvt_pk_bf16_f32 v120, v132, v148
v_cvt_pk_bf16_f32 v121, v164, v180
v_cvt_pk_bf16_f32 v122, v133, v149
v_cvt_pk_bf16_f32 v123, v165, v181
v_mfma_f32_32x32x16_bf16 v[240:255], v[44:47], v[60:63], v[240:255]
v_permlane16_swap_b32 v116, v118
v_permlane16_swap_b32 v117, v119
buffer_store_dwordx4 v[116:119], v11, s[52:55], s33 offen sc1
v_cvt_pk_bf16_f32 v124, v134, v150
v_mfma_f32_32x32x16_bf16 v[192:207], v[68:71], v[72:75], v[192:207]
v_cvt_pk_bf16_f32 v125, v166, v182
v_cvt_pk_bf16_f32 v126, v135, v151
v_cvt_pk_bf16_f32 v127, v167, v183
v_permlane16_swap_b32 v120, v122
v_permlane16_swap_b32 v121, v123
v_mfma_f32_32x32x16_bf16 v[208:223], v[68:71], v[76:79], v[208:223]
buffer_store_dwordx4 v[120:123], v11, s[52:55], s34 offen sc1
v_cvt_pk_bf16_f32 v112, v136, v152
v_cvt_pk_bf16_f32 v113, v168, v184
v_cvt_pk_bf16_f32 v114, v137, v153
v_cvt_pk_bf16_f32 v115, v169, v185
v_mfma_f32_32x32x16_bf16 v[224:239], v[68:71], v[80:83], v[224:239]
v_permlane16_swap_b32 v124, v126
v_permlane16_swap_b32 v125, v127
buffer_store_dwordx4 v[124:127], v11, s[52:55], s35 offen sc1
v_cvt_pk_bf16_f32 v116, v138, v154
v_cvt_pk_bf16_f32 v117, v170, v186
v_mfma_f32_32x32x16_bf16 v[240:255], v[68:71], v[84:87], v[240:255]
v_cvt_pk_bf16_f32 v118, v139, v155
v_cvt_pk_bf16_f32 v119, v171, v187
v_permlane16_swap_b32 v112, v114
v_permlane16_swap_b32 v113, v115
v_mfma_f32_32x32x16_bf16 v[192:207], v[92:95], v[96:99], v[192:207]
buffer_store_dwordx4 v[112:115], v11, s[52:55], s36 offen sc1
v_cvt_pk_bf16_f32 v120, v140, v156
v_cvt_pk_bf16_f32 v121, v172, v188
v_cvt_pk_bf16_f32 v122, v141, v157
v_cvt_pk_bf16_f32 v123, v173, v189
v_mfma_f32_32x32x16_bf16 v[208:223], v[92:95], v[100:103], v[208:223]
v_permlane16_swap_b32 v116, v118
v_permlane16_swap_b32 v117, v119
buffer_store_dwordx4 v[116:119], v11, s[52:55], s37 offen sc1
v_cvt_pk_bf16_f32 v124, v142, v158
v_cvt_pk_bf16_f32 v125, v174, v190
v_mfma_f32_32x32x16_bf16 v[224:239], v[92:95], v[104:107], v[224:239]
v_cvt_pk_bf16_f32 v126, v143, v159
v_cvt_pk_bf16_f32 v127, v175, v191
v_permlane16_swap_b32 v120, v122
v_permlane16_swap_b32 v121, v123
buffer_store_dwordx4 v[120:123], v11, s[52:55], s38 offen sc1
v_mfma_f32_32x32x16_bf16 v[240:255], v[92:95], v[108:111], v[240:255]
s_nop 1
v_permlane16_swap_b32 v124, v126
v_permlane16_swap_b32 v125, v127
buffer_store_dwordx4 v[124:127], v11, s[52:55], s39 offen sc1
s_nop 15
v_cvt_pk_bf16_f32 v16, v192, v208
v_cvt_pk_bf16_f32 v17, v224, v240
v_cvt_pk_bf16_f32 v18, v193, v209
v_cvt_pk_bf16_f32 v19, v225, v241
v_cvt_pk_bf16_f32 v20, v194, v210
v_cvt_pk_bf16_f32 v21, v226, v242
v_cvt_pk_bf16_f32 v22, v195, v211
v_cvt_pk_bf16_f32 v23, v227, v243
v_permlane16_swap_b32 v16, v18
v_permlane16_swap_b32 v17, v19
buffer_store_dwordx4 v[16:19], v11, s[24:27], s32 offen sc1
v_cvt_pk_bf16_f32 v24, v196, v212
v_cvt_pk_bf16_f32 v25, v228, v244
v_cvt_pk_bf16_f32 v26, v197, v213
v_cvt_pk_bf16_f32 v27, v229, v245
v_permlane16_swap_b32 v20, v22
v_permlane16_swap_b32 v21, v23
buffer_store_dwordx4 v[20:23], v11, s[24:27], s33 offen sc1
v_cvt_pk_bf16_f32 v28, v198, v214
v_cvt_pk_bf16_f32 v29, v230, v246
v_cvt_pk_bf16_f32 v30, v199, v215
v_cvt_pk_bf16_f32 v31, v231, v247
v_permlane16_swap_b32 v24, v26
v_permlane16_swap_b32 v25, v27
buffer_store_dwordx4 v[24:27], v11, s[24:27], s34 offen sc1
v_cvt_pk_bf16_f32 v32, v200, v216
v_cvt_pk_bf16_f32 v33, v232, v248
v_cvt_pk_bf16_f32 v34, v201, v217
v_cvt_pk_bf16_f32 v35, v233, v249
v_permlane16_swap_b32 v28, v30
v_permlane16_swap_b32 v29, v31
buffer_store_dwordx4 v[28:31], v11, s[24:27], s35 offen sc1
v_cvt_pk_bf16_f32 v36, v202, v218
v_cvt_pk_bf16_f32 v37, v234, v250
v_cvt_pk_bf16_f32 v38, v203, v219
v_cvt_pk_bf16_f32 v39, v235, v251
v_permlane16_swap_b32 v32, v34
v_permlane16_swap_b32 v33, v35
buffer_store_dwordx4 v[32:35], v11, s[24:27], s36 offen sc1
v_cvt_pk_bf16_f32 v40, v204, v220
v_cvt_pk_bf16_f32 v41, v236, v252
v_cvt_pk_bf16_f32 v42, v205, v221
v_cvt_pk_bf16_f32 v43, v237, v253
v_permlane16_swap_b32 v36, v38
v_permlane16_swap_b32 v37, v39
buffer_store_dwordx4 v[36:39], v11, s[24:27], s37 offen sc1
v_cvt_pk_bf16_f32 v44, v206, v222
v_cvt_pk_bf16_f32 v45, v238, v254
v_cvt_pk_bf16_f32 v46, v207, v223
v_cvt_pk_bf16_f32 v47, v239, v255
v_permlane16_swap_b32 v40, v42
v_permlane16_swap_b32 v41, v43
buffer_store_dwordx4 v[40:43], v11, s[24:27], s38 offen sc1
s_nop 1
v_permlane16_swap_b32 v44, v46
v_permlane16_swap_b32 v45, v47
buffer_store_dwordx4 v[44:47], v11, s[24:27], s39 offen sc1
s_endpgm
L_prod:
s_sub_u32 s3, s3, 4
v_and_b32 v5, 31, v0
v_lshrrev_b32 v6, 5, v0
s_lshl_b32 s48, s3, 1
v_add_u32 v7, s48, v6
v_mul_u32_u24 v1, 114688, v7
v_lshlrev_b32 v8, 4, v5
v_add_u32 v1, v1, v8
s_mov_b32 s32, 0
s_mov_b32 s33, 14336
s_mov_b32 s34, 28672
s_mov_b32 s35, 43008
s_mov_b32 s36, 57344
s_mov_b32 s37, 71680
s_mov_b32 s38, 86016
s_mov_b32 s39, 100352
s_mov_b32 s23, 0x20000
s_lshl_b32 s49, s29, 9
s_waitcnt lgkmcnt(0)
s_add_u32 s86, s6, s49
s_addc_u32 s87, s7, 0
s_sub_u32 s88, 14680064, s49
s_bfe_u32 s89, s96, 262144
s_mul_i32 s90, s89, 917504
s_add_u32 s20, s86, s90
s_addc_u32 s21, s87, 0
s_sub_u32 s22, s88, s90
buffer_load_dwordx4 v[112:115], v1, s[20:23], s32 offen
buffer_load_dwordx4 v[116:119], v1, s[20:23], s33 offen
buffer_load_dwordx4 v[120:123], v1, s[20:23], s34 offen
buffer_load_dwordx4 v[124:127], v1, s[20:23], s35 offen
buffer_load_dwordx4 v[128:131], v1, s[20:23], s36 offen
buffer_load_dwordx4 v[132:135], v1, s[20:23], s37 offen
buffer_load_dwordx4 v[136:139], v1, s[20:23], s38 offen
buffer_load_dwordx4 v[140:143], v1, s[20:23], s39 offen
s_bfe_u32 s89, s96, 262148
s_mul_i32 s90, s89, 917504
s_add_u32 s20, s86, s90
s_addc_u32 s21, s87, 0
s_sub_u32 s22, s88, s90
buffer_load_dwordx4 v[144:147], v1, s[20:23], s32 offen
buffer_load_dwordx4 v[148:151], v1, s[20:23], s33 offen
buffer_load_dwordx4 v[152:155], v1, s[20:23], s34 offen
buffer_load_dwordx4 v[156:159], v1, s[20:23], s35 offen
buffer_load_dwordx4 v[160:163], v1, s[20:23], s36 offen
buffer_load_dwordx4 v[164:167], v1, s[20:23], s37 offen
buffer_load_dwordx4 v[168:171], v1, s[20:23], s38 offen
buffer_load_dwordx4 v[172:175], v1, s[20:23], s39 offen
v_lshrrev_b32 v8, 1, v5
v_and_b32 v9, 1, v5
v_lshlrev_b32 v10, 4, v9
v_add_u32 v8, v8, v10
v_mul_u32_u24 v9, 12, v9
v_xor_b32 v8, v8, v9
v_lshlrev_b32 v8, 4, v8
v_lshlrev_b32 v9, 11, v7
v_add_u32 v8, v8, v9
v_add_u32 v4, 131072, v8
v_lshlrev_b32 v8, 3, v5
v_add_u32 v8, 147456, v8
v_lshrrev_b32 v9, 3, v0
v_and_b32 v9, 1, v9
v_lshlrev_b32 v9, 6, v9
v_lshlrev_b32 v10, 3, v7
v_add_u32 v9, v9, v10
v_and_b32 v10, 7, v0
v_add_u32 v9, v9, v10
v_lshlrev_b32 v9, 1, v9
v_add_u32 v9, 151552, v9
s_barrier
ds_read_b64 v[208:209], v8 offset:0
ds_read_b64 v[210:211], v8 offset:2048
ds_read_b64 v[212:213], v8 offset:256
ds_read_b64 v[214:215], v8 offset:2304
ds_read_b64 v[216:217], v8 offset:512
ds_read_b64 v[218:219], v8 offset:2560
ds_read_b64 v[220:221], v8 offset:768
ds_read_b64 v[222:223], v8 offset:2816
ds_read_b64 v[224:225], v8 offset:1024
ds_read_b64 v[226:227], v8 offset:3072
ds_read_b64 v[228:229], v8 offset:1280
ds_read_b64 v[230:231], v8 offset:3328
ds_read_b64 v[232:233], v8 offset:1536
ds_read_b64 v[234:235], v8 offset:3584
s_waitcnt lgkmcnt(4)
ds_read_b64 v[236:237], v8 offset:1792
ds_read_b64 v[238:239], v8 offset:3840
ds_read_u16 v32, v9 offset:0
ds_read_u16 v33, v9 offset:256
ds_read_u16 v34, v9 offset:512
ds_read_u16 v35, v9 offset:768
ds_read_u16 v36, v9 offset:1024
ds_read_u16 v37, v9 offset:1280
ds_read_u16 v38, v9 offset:1536
ds_read_u16 v39, v9 offset:1792
s_waitcnt lgkmcnt(10)
v_lshlrev_b32 v40, 16, v208
v_and_b32 v41, 0xffff0000, v208
v_lshlrev_b32 v44, 16, v210
v_and_b32 v45, 0xffff0000, v210
v_lshlrev_b32 v42, 16, v209
v_and_b32 v43, 0xffff0000, v209
v_lshlrev_b32 v46, 16, v211
v_and_b32 v47, 0xffff0000, v211
v_mul_f32_e64 v44, -v44, v40
v_mul_f32_e64 v45, -v45, v41
v_mul_f32_e64 v46, -v46, v42
v_mul_f32_e64 v47, -v47, v43
s_waitcnt lgkmcnt(0)
v_lshlrev_b32 v32, 16, v32
v_lshlrev_b32 v33, 16, v33
v_lshlrev_b32 v34, 16, v34
v_lshlrev_b32 v35, 16, v35
v_lshlrev_b32 v36, 16, v36
v_lshlrev_b32 v37, 16, v37
v_lshlrev_b32 v38, 16, v38
v_lshlrev_b32 v39, 16, v39
s_waitcnt vmcnt(8)
v_cvt_f32_i32 v112, v112
v_cvt_f32_i32 v116, v116
v_cvt_f32_i32 v120, v120
v_cvt_f32_i32 v124, v124
v_cvt_f32_i32 v128, v128
v_cvt_f32_i32 v132, v132
v_cvt_f32_i32 v136, v136
v_cvt_f32_i32 v140, v140
v_fma_f32 v112, v112, v40, v44
v_fma_f32 v116, v116, v40, v44
v_fma_f32 v120, v120, v40, v44
v_fma_f32 v124, v124, v40, v44
v_fma_f32 v128, v128, v40, v44
v_fma_f32 v132, v132, v40, v44
v_fma_f32 v136, v136, v40, v44
v_fma_f32 v140, v140, v40, v44
v_mul_f32_dpp v112, v32, v112 row_newbcast:0 row_mask:0xf bank_mask:0xf
v_mul_f32_dpp v116, v32, v116 row_newbcast:1 row_mask:0xf bank_mask:0xf
v_mul_f32_dpp v120, v32, v120 row_newbcast:2 row_mask:0xf bank_mask:0xf
v_mul_f32_dpp v124, v32, v124 row_newbcast:3 row_mask:0xf bank_mask:0xf
v_mul_f32_dpp v128, v32, v128 row_newbcast:4 row_mask:0xf bank_mask:0xf
v_mul_f32_dpp v132, v32, v132 row_newbcast:5 row_mask:0xf bank_mask:0xf
v_mul_f32_dpp v136, v32, v136 row_newbcast:6 row_mask:0xf bank_mask:0xf
v_mul_f32_dpp v140, v32, v140 row_newbcast:7 row_mask:0xf bank_mask:0xf
v_cvt_pk_bf16_f32 v16, v112, v116
v_cvt_pk_bf16_f32 v17, v120, v124
v_cvt_pk_bf16_f32 v18, v128, v132
v_cvt_pk_bf16_f32 v19, v136, v140
ds_write_b128 v4, v[16:19] offset:0
v_cvt_f32_i32 v113, v113
v_cvt_f32_i32 v117, v117
v_cvt_f32_i32 v121, v121
v_cvt_f32_i32 v125, v125
v_cvt_f32_i32 v129, v129
v_cvt_f32_i32 v133, v133
v_cvt_f32_i32 v137, v137
v_cvt_f32_i32 v141, v141
v_fma_f32 v113, v113, v41, v45
v_fma_f32 v117, v117, v41, v45
v_fma_f32 v121, v121, v41, v45
v_fma_f32 v125, v125, v41, v45
v_fma_f32 v129, v129, v41, v45
v_fma_f32 v133, v133, v41, v45
v_fma_f32 v137, v137, v41, v45
v_fma_f32 v141, v141, v41, v45
v_mul_f32_dpp v113, v32, v113 row_newbcast:0 row_mask:0xf bank_mask:0xf
v_mul_f32_dpp v117, v32, v117 row_newbcast:1 row_mask:0xf bank_mask:0xf
v_mul_f32_dpp v121, v32, v121 row_newbcast:2 row_mask:0xf bank_mask:0xf
v_mul_f32_dpp v125, v32, v125 row_newbcast:3 row_mask:0xf bank_mask:0xf
v_mul_f32_dpp v129, v32, v129 row_newbcast:4 row_mask:0xf bank_mask:0xf
v_mul_f32_dpp v133, v32, v133 row_newbcast:5 row_mask:0xf bank_mask:0xf
v_mul_f32_dpp v137, v32, v137 row_newbcast:6 row_mask:0xf bank_mask:0xf
v_mul_f32_dpp v141, v32, v141 row_newbcast:7 row_mask:0xf bank_mask:0xf
v_cvt_pk_bf16_f32 v20, v113, v117
v_cvt_pk_bf16_f32 v21, v121, v125
v_cvt_pk_bf16_f32 v22, v129, v133
v_cvt_pk_bf16_f32 v23, v137, v141
ds_write_b128 v4, v[20:23] offset:512
v_cvt_f32_i32 v114, v114
v_cvt_f32_i32 v118, v118
v_cvt_f32_i32 v122, v122
v_cvt_f32_i32 v126, v126
v_cvt_f32_i32 v130, v130
v_cvt_f32_i32 v134, v134
v_cvt_f32_i32 v138, v138
v_cvt_f32_i32 v142, v142
v_fma_f32 v114, v114, v42, v46
v_fma_f32 v118, v118, v42, v46
v_fma_f32 v122, v122, v42, v46
v_fma_f32 v126, v126, v42, v46
v_fma_f32 v130, v130, v42, v46
v_fma_f32 v134, v134, v42, v46
v_fma_f32 v138, v138, v42, v46
v_fma_f32 v142, v142, v42, v46
v_mul_f32_dpp v114, v32, v114 row_newbcast:0 row_mask:0xf bank_mask:0xf
v_mul_f32_dpp v118, v32, v118 row_newbcast:1 row_mask:0xf bank_mask:0xf
v_mul_f32_dpp v122, v32, v122 row_newbcast:2 row_mask:0xf bank_mask:0xf
v_mul_f32_dpp v126, v32, v126 row_newbcast:3 row_mask:0xf bank_mask:0xf
v_mul_f32_dpp v130, v32, v130 row_newbcast:4 row_mask:0xf bank_mask:0xf
v_mul_f32_dpp v134, v32, v134 row_newbcast:5 row_mask:0xf bank_mask:0xf
v_mul_f32_dpp v138, v32, v138 row_newbcast:6 row_mask:0xf bank_mask:0xf
v_mul_f32_dpp v142, v32, v142 row_newbcast:7 row_mask:0xf bank_mask:0xf
v_cvt_pk_bf16_f32 v24, v114, v118
v_cvt_pk_bf16_f32 v25, v122, v126
v_cvt_pk_bf16_f32 v26, v130, v134
v_cvt_pk_bf16_f32 v27, v138, v142
ds_write_b128 v4, v[24:27] offset:1024
v_cvt_f32_i32 v115, v115
v_cvt_f32_i32 v119, v119
v_cvt_f32_i32 v123, v123
v_cvt_f32_i32 v127, v127
v_cvt_f32_i32 v131, v131
v_cvt_f32_i32 v135, v135
v_cvt_f32_i32 v139, v139
v_cvt_f32_i32 v143, v143
v_fma_f32 v115, v115, v43, v47
v_fma_f32 v119, v119, v43, v47
v_fma_f32 v123, v123, v43, v47
v_fma_f32 v127, v127, v43, v47
v_fma_f32 v131, v131, v43, v47
v_fma_f32 v135, v135, v43, v47
v_fma_f32 v139, v139, v43, v47
v_fma_f32 v143, v143, v43, v47
v_mul_f32_dpp v115, v32, v115 row_newbcast:0 row_mask:0xf bank_mask:0xf
v_mul_f32_dpp v119, v32, v119 row_newbcast:1 row_mask:0xf bank_mask:0xf
v_mul_f32_dpp v123, v32, v123 row_newbcast:2 row_mask:0xf bank_mask:0xf
v_mul_f32_dpp v127, v32, v127 row_newbcast:3 row_mask:0xf bank_mask:0xf
v_mul_f32_dpp v131, v32, v131 row_newbcast:4 row_mask:0xf bank_mask:0xf
v_mul_f32_dpp v135, v32, v135 row_newbcast:5 row_mask:0xf bank_mask:0xf
v_mul_f32_dpp v139, v32, v139 row_newbcast:6 row_mask:0xf bank_mask:0xf
v_mul_f32_dpp v143, v32, v143 row_newbcast:7 row_mask:0xf bank_mask:0xf
v_cvt_pk_bf16_f32 v28, v115, v119
v_cvt_pk_bf16_f32 v29, v123, v127
v_cvt_pk_bf16_f32 v30, v131, v135
v_cvt_pk_bf16_f32 v31, v139, v143
ds_write_b128 v4, v[28:31] offset:1536
s_waitcnt lgkmcnt(0)
s_barrier
v_lshlrev_b32 v48, 16, v212
v_and_b32 v49, 0xffff0000, v212
v_lshlrev_b32 v52, 16, v214
v_and_b32 v53, 0xffff0000, v214
v_lshlrev_b32 v50, 16, v213
v_and_b32 v51, 0xffff0000, v213
v_lshlrev_b32 v54, 16, v215
v_and_b32 v55, 0xffff0000, v215
v_mul_f32_e64 v52, -v52, v48
v_mul_f32_e64 v53, -v53, v49
v_mul_f32_e64 v54, -v54, v50
v_mul_f32_e64 v55, -v55, v51
s_waitcnt vmcnt(0)
v_cvt_f32_i32 v144, v144
v_cvt_f32_i32 v148, v148
v_cvt_f32_i32 v152, v152
v_cvt_f32_i32 v156, v156
s_bfe_u32 s89, s96, 262152
s_mul_i32 s90, s89, 917504
s_add_u32 s20, s86, s90
s_addc_u32 s21, s87, 0
s_sub_u32 s22, s88, s90
buffer_load_dwordx4 v[176:179], v1, s[20:23], s32 offen
v_cvt_f32_i32 v160, v160
v_cvt_f32_i32 v164, v164
v_cvt_f32_i32 v168, v168
v_cvt_f32_i32 v172, v172
v_fma_f32 v144, v144, v40, v44
v_fma_f32 v148, v148, v40, v44
v_fma_f32 v152, v152, v40, v44
buffer_load_dwordx4 v[180:183], v1, s[20:23], s33 offen
v_fma_f32 v156, v156, v40, v44
v_fma_f32 v160, v160, v40, v44
v_fma_f32 v164, v164, v40, v44
v_fma_f32 v168, v168, v40, v44
v_fma_f32 v172, v172, v40, v44
v_mul_f32_dpp v144, v32, v144 row_newbcast:8 row_mask:0xf bank_mask:0xf
v_mul_f32_dpp v148, v32, v148 row_newbcast:9 row_mask:0xf bank_mask:0xf
buffer_load_dwordx4 v[184:187], v1, s[20:23], s34 offen
v_mul_f32_dpp v152, v32, v152 row_newbcast:10 row_mask:0xf bank_mask:0xf
v_mul_f32_dpp v156, v32, v156 row_newbcast:11 row_mask:0xf bank_mask:0xf
v_mul_f32_dpp v160, v32, v160 row_newbcast:12 row_mask:0xf bank_mask:0xf
v_mul_f32_dpp v164, v32, v164 row_newbcast:13 row_mask:0xf bank_mask:0xf
v_mul_f32_dpp v168, v32, v168 row_newbcast:14 row_mask:0xf bank_mask:0xf
v_mul_f32_dpp v172, v32, v172 row_newbcast:15 row_mask:0xf bank_mask:0xf
v_cvt_pk_bf16_f32 v16, v144, v148
buffer_load_dwordx4 v[188:191], v1, s[20:23], s35 offen
v_cvt_pk_bf16_f32 v17, v152, v156
v_cvt_pk_bf16_f32 v18, v160, v164
v_cvt_pk_bf16_f32 v19, v168, v172
ds_write_b128 v4, v[16:19] offset:16384
v_cvt_f32_i32 v145, v145
v_cvt_f32_i32 v149, v149
v_cvt_f32_i32 v153, v153
v_cvt_f32_i32 v157, v157
buffer_load_dwordx4 v[192:195], v1, s[20:23], s36 offen
v_cvt_f32_i32 v161, v161
v_cvt_f32_i32 v165, v165
v_cvt_f32_i32 v169, v169
v_cvt_f32_i32 v173, v173
v_fma_f32 v145, v145, v41, v45
v_fma_f32 v149, v149, v41, v45
v_fma_f32 v153, v153, v41, v45
buffer_load_dwordx4 v[196:199], v1, s[20:23], s37 offen
v_fma_f32 v157, v157, v41, v45
v_fma_f32 v161, v161, v41, v45
v_fma_f32 v165, v165, v41, v45
v_fma_f32 v169, v169, v41, v45
v_fma_f32 v173, v173, v41, v45
v_mul_f32_dpp v145, v32, v145 row_newbcast:8 row_mask:0xf bank_mask:0xf
v_mul_f32_dpp v149, v32, v149 row_newbcast:9 row_mask:0xf bank_mask:0xf
buffer_load_dwordx4 v[200:203], v1, s[20:23], s38 offen
v_mul_f32_dpp v153, v32, v153 row_newbcast:10 row_mask:0xf bank_mask:0xf
v_mul_f32_dpp v157, v32, v157 row_newbcast:11 row_mask:0xf bank_mask:0xf
v_mul_f32_dpp v161, v32, v161 row_newbcast:12 row_mask:0xf bank_mask:0xf
v_mul_f32_dpp v165, v32, v165 row_newbcast:13 row_mask:0xf bank_mask:0xf
v_mul_f32_dpp v169, v32, v169 row_newbcast:14 row_mask:0xf bank_mask:0xf
v_mul_f32_dpp v173, v32, v173 row_newbcast:15 row_mask:0xf bank_mask:0xf
v_cvt_pk_bf16_f32 v20, v145, v149
buffer_load_dwordx4 v[204:207], v1, s[20:23], s39 offen
v_cvt_pk_bf16_f32 v21, v153, v157
v_cvt_pk_bf16_f32 v22, v161, v165
v_cvt_pk_bf16_f32 v23, v169, v173
ds_write_b128 v4, v[20:23] offset:16896
v_cvt_f32_i32 v146, v146
v_cvt_f32_i32 v150, v150
v_cvt_f32_i32 v154, v154
v_cvt_f32_i32 v158, v158
s_bfe_u32 s89, s96, 262156
s_mul_i32 s90, s89, 917504
s_add_u32 s20, s86, s90
s_addc_u32 s21, s87, 0
s_sub_u32 s22, s88, s90
buffer_load_dwordx4 v[112:115], v1, s[20:23], s32 offen
v_cvt_f32_i32 v162, v162
v_cvt_f32_i32 v166, v166
v_cvt_f32_i32 v170, v170
v_cvt_f32_i32 v174, v174
v_fma_f32 v146, v146, v42, v46
v_fma_f32 v150, v150, v42, v46
v_fma_f32 v154, v154, v42, v46
buffer_load_dwordx4 v[116:119], v1, s[20:23], s33 offen
v_fma_f32 v158, v158, v42, v46
v_fma_f32 v162, v162, v42, v46
v_fma_f32 v166, v166, v42, v46
v_fma_f32 v170, v170, v42, v46
v_fma_f32 v174, v174, v42, v46
v_mul_f32_dpp v146, v32, v146 row_newbcast:8 row_mask:0xf bank_mask:0xf
v_mul_f32_dpp v150, v32, v150 row_newbcast:9 row_mask:0xf bank_mask:0xf
buffer_load_dwordx4 v[120:123], v1, s[20:23], s34 offen
v_mul_f32_dpp v154, v32, v154 row_newbcast:10 row_mask:0xf bank_mask:0xf
v_mul_f32_dpp v158, v32, v158 row_newbcast:11 row_mask:0xf bank_mask:0xf
v_mul_f32_dpp v162, v32, v162 row_newbcast:12 row_mask:0xf bank_mask:0xf
v_mul_f32_dpp v166, v32, v166 row_newbcast:13 row_mask:0xf bank_mask:0xf
v_mul_f32_dpp v170, v32, v170 row_newbcast:14 row_mask:0xf bank_mask:0xf
v_mul_f32_dpp v174, v32, v174 row_newbcast:15 row_mask:0xf bank_mask:0xf
v_cvt_pk_bf16_f32 v24, v146, v150
buffer_load_dwordx4 v[124:127], v1, s[20:23], s35 offen
v_cvt_pk_bf16_f32 v25, v154, v158
v_cvt_pk_bf16_f32 v26, v162, v166
v_cvt_pk_bf16_f32 v27, v170, v174
ds_write_b128 v4, v[24:27] offset:17408
v_cvt_f32_i32 v147, v147
v_cvt_f32_i32 v151, v151
v_cvt_f32_i32 v155, v155
v_cvt_f32_i32 v159, v159
buffer_load_dwordx4 v[128:131], v1, s[20:23], s36 offen
v_cvt_f32_i32 v163, v163
v_cvt_f32_i32 v167, v167
v_cvt_f32_i32 v171, v171
v_cvt_f32_i32 v175, v175
v_fma_f32 v147, v147, v43, v47
v_fma_f32 v151, v151, v43, v47
v_fma_f32 v155, v155, v43, v47
buffer_load_dwordx4 v[132:135], v1, s[20:23], s37 offen
v_fma_f32 v159, v159, v43, v47
v_fma_f32 v163, v163, v43, v47
v_fma_f32 v167, v167, v43, v47
v_fma_f32 v171, v171, v43, v47
v_fma_f32 v175, v175, v43, v47
v_mul_f32_dpp v147, v32, v147 row_newbcast:8 row_mask:0xf bank_mask:0xf
v_mul_f32_dpp v151, v32, v151 row_newbcast:9 row_mask:0xf bank_mask:0xf
buffer_load_dwordx4 v[136:139], v1, s[20:23], s38 offen
v_mul_f32_dpp v155, v32, v155 row_newbcast:10 row_mask:0xf bank_mask:0xf
v_mul_f32_dpp v159, v32, v159 row_newbcast:11 row_mask:0xf bank_mask:0xf
v_mul_f32_dpp v163, v32, v163 row_newbcast:12 row_mask:0xf bank_mask:0xf
v_mul_f32_dpp v167, v32, v167 row_newbcast:13 row_mask:0xf bank_mask:0xf
v_mul_f32_dpp v171, v32, v171 row_newbcast:14 row_mask:0xf bank_mask:0xf
v_mul_f32_dpp v175, v32, v175 row_newbcast:15 row_mask:0xf bank_mask:0xf
v_cvt_pk_bf16_f32 v28, v147, v151
buffer_load_dwordx4 v[140:143], v1, s[20:23], s39 offen
v_cvt_pk_bf16_f32 v29, v155, v159
v_cvt_pk_bf16_f32 v30, v163, v167
v_cvt_pk_bf16_f32 v31, v171, v175
ds_write_b128 v4, v[28:31] offset:17920
s_waitcnt vmcnt(8)
v_cvt_f32_i32 v176, v176
v_cvt_f32_i32 v180, v180
v_cvt_f32_i32 v184, v184
v_cvt_f32_i32 v188, v188
v_cvt_f32_i32 v192, v192
v_cvt_f32_i32 v196, v196
v_cvt_f32_i32 v200, v200
s_bfe_u32 s89, s96, 262160
s_mul_i32 s90, s89, 917504
s_add_u32 s20, s86, s90
s_addc_u32 s21, s87, 0
s_sub_u32 s22, s88, s90
buffer_load_dwordx4 v[144:147], v1, s[20:23], s32 offen
v_cvt_f32_i32 v204, v204
v_fma_f32 v176, v176, v48, v52
v_fma_f32 v180, v180, v48, v52
v_fma_f32 v184, v184, v48, v52
v_fma_f32 v188, v188, v48, v52
v_fma_f32 v192, v192, v48, v52
v_fma_f32 v196, v196, v48, v52
v_fma_f32 v200, v200, v48, v52
v_fma_f32 v204, v204, v48, v52
v_mul_f32_dpp v176, v33, v176 row_newbcast:0 row_mask:0xf bank_mask:0xf
v_mul_f32_dpp v180, v33, v180 row_newbcast:1 row_mask:0xf bank_mask:0xf
v_mul_f32_dpp v184, v33, v184 row_newbcast:2 row_mask:0xf bank_mask:0xf
v_mul_f32_dpp v188, v33, v188 row_newbcast:3 row_mask:0xf bank_mask:0xf
v_mul_f32_dpp v192, v33, v192 row_newbcast:4 row_mask:0xf bank_mask:0xf
buffer_load_dwordx4 v[148:151], v1, s[20:23], s33 offen
v_mul_f32_dpp v196, v33, v196 row_newbcast:5 row_mask:0xf bank_mask:0xf
v_mul_f32_dpp v200, v33, v200 row_newbcast:6 row_mask:0xf bank_mask:0xf
v_mul_f32_dpp v204, v33, v204 row_newbcast:7 row_mask:0xf bank_mask:0xf
v_cvt_pk_bf16_f32 v16, v176, v180
v_cvt_pk_bf16_f32 v17, v184, v188
v_cvt_pk_bf16_f32 v18, v192, v196
v_cvt_pk_bf16_f32 v19, v200, v204
s_waitcnt lgkmcnt(0)
s_barrier
ds_write_b128 v4, v[16:19] offset:0
v_cvt_f32_i32 v177, v177
v_cvt_f32_i32 v181, v181
v_cvt_f32_i32 v185, v185
v_cvt_f32_i32 v189, v189
v_cvt_f32_i32 v193, v193
v_cvt_f32_i32 v197, v197
v_cvt_f32_i32 v201, v201
buffer_load_dwordx4 v[152:155], v1, s[20:23], s34 offen
v_cvt_f32_i32 v205, v205
v_fma_f32 v177, v177, v49, v53
v_fma_f32 v181, v181, v49, v53
v_fma_f32 v185, v185, v49, v53
v_fma_f32 v189, v189, v49, v53
v_fma_f32 v193, v193, v49, v53
v_fma_f32 v197, v197, v49, v53
v_fma_f32 v201, v201, v49, v53
v_fma_f32 v205, v205, v49, v53
v_mul_f32_dpp v177, v33, v177 row_newbcast:0 row_mask:0xf bank_mask:0xf
v_mul_f32_dpp v181, v33, v181 row_newbcast:1 row_mask:0xf bank_mask:0xf
v_mul_f32_dpp v185, v33, v185 row_newbcast:2 row_mask:0xf bank_mask:0xf
v_mul_f32_dpp v189, v33, v189 row_newbcast:3 row_mask:0xf bank_mask:0xf
v_mul_f32_dpp v193, v33, v193 row_newbcast:4 row_mask:0xf bank_mask:0xf
buffer_load_dwordx4 v[156:159], v1, s[20:23], s35 offen
v_mul_f32_dpp v197, v33, v197 row_newbcast:5 row_mask:0xf bank_mask:0xf
v_mul_f32_dpp v201, v33, v201 row_newbcast:6 row_mask:0xf bank_mask:0xf
v_mul_f32_dpp v205, v33, v205 row_newbcast:7 row_mask:0xf bank_mask:0xf
v_cvt_pk_bf16_f32 v20, v177, v181
v_cvt_pk_bf16_f32 v21, v185, v189
v_cvt_pk_bf16_f32 v22, v193, v197
v_cvt_pk_bf16_f32 v23, v201, v205
ds_write_b128 v4, v[20:23] offset:512
v_cvt_f32_i32 v178, v178
v_cvt_f32_i32 v182, v182
v_cvt_f32_i32 v186, v186
v_cvt_f32_i32 v190, v190
v_cvt_f32_i32 v194, v194
v_cvt_f32_i32 v198, v198
v_cvt_f32_i32 v202, v202
buffer_load_dwordx4 v[160:163], v1, s[20:23], s36 offen
v_cvt_f32_i32 v206, v206
v_fma_f32 v178, v178, v50, v54
v_fma_f32 v182, v182, v50, v54
v_fma_f32 v186, v186, v50, v54
v_fma_f32 v190, v190, v50, v54
v_fma_f32 v194, v194, v50, v54
v_fma_f32 v198, v198, v50, v54
v_fma_f32 v202, v202, v50, v54
v_fma_f32 v206, v206, v50, v54
v_mul_f32_dpp v178, v33, v178 row_newbcast:0 row_mask:0xf bank_mask:0xf
v_mul_f32_dpp v182, v33, v182 row_newbcast:1 row_mask:0xf bank_mask:0xf
v_mul_f32_dpp v186, v33, v186 row_newbcast:2 row_mask:0xf bank_mask:0xf
v_mul_f32_dpp v190, v33, v190 row_newbcast:3 row_mask:0xf bank_mask:0xf
v_mul_f32_dpp v194, v33, v194 row_newbcast:4 row_mask:0xf bank_mask:0xf
buffer_load_dwordx4 v[164:167], v1, s[20:23], s37 offen
v_mul_f32_dpp v198, v33, v198 row_newbcast:5 row_mask:0xf bank_mask:0xf
v_mul_f32_dpp v202, v33, v202 row_newbcast:6 row_mask:0xf bank_mask:0xf
v_mul_f32_dpp v206, v33, v206 row_newbcast:7 row_mask:0xf bank_mask:0xf
v_cvt_pk_bf16_f32 v24, v178, v182
v_cvt_pk_bf16_f32 v25, v186, v190
v_cvt_pk_bf16_f32 v26, v194, v198
v_cvt_pk_bf16_f32 v27, v202, v206
ds_write_b128 v4, v[24:27] offset:1024
v_cvt_f32_i32 v179, v179
v_cvt_f32_i32 v183, v183
v_cvt_f32_i32 v187, v187
v_cvt_f32_i32 v191, v191
v_cvt_f32_i32 v195, v195
v_cvt_f32_i32 v199, v199
v_cvt_f32_i32 v203, v203
buffer_load_dwordx4 v[168:171], v1, s[20:23], s38 offen
v_cvt_f32_i32 v207, v207
v_fma_f32 v179, v179, v51, v55
v_fma_f32 v183, v183, v51, v55
v_fma_f32 v187, v187, v51, v55
v_fma_f32 v191, v191, v51, v55
v_fma_f32 v195, v195, v51, v55
v_fma_f32 v199, v199, v51, v55
v_fma_f32 v203, v203, v51, v55
v_fma_f32 v207, v207, v51, v55
v_mul_f32_dpp v179, v33, v179 row_newbcast:0 row_mask:0xf bank_mask:0xf
v_mul_f32_dpp v183, v33, v183 row_newbcast:1 row_mask:0xf bank_mask:0xf
v_mul_f32_dpp v187, v33, v187 row_newbcast:2 row_mask:0xf bank_mask:0xf
v_mul_f32_dpp v191, v33, v191 row_newbcast:3 row_mask:0xf bank_mask:0xf
v_mul_f32_dpp v195, v33, v195 row_newbcast:4 row_mask:0xf bank_mask:0xf
buffer_load_dwordx4 v[172:175], v1, s[20:23], s39 offen
v_mul_f32_dpp v199, v33, v199 row_newbcast:5 row_mask:0xf bank_mask:0xf
v_mul_f32_dpp v203, v33, v203 row_newbcast:6 row_mask:0xf bank_mask:0xf
v_mul_f32_dpp v207, v33, v207 row_newbcast:7 row_mask:0xf bank_mask:0xf
v_cvt_pk_bf16_f32 v28, v179, v183
v_cvt_pk_bf16_f32 v29, v187, v191
v_cvt_pk_bf16_f32 v30, v195, v199
v_cvt_pk_bf16_f32 v31, v203, v207
ds_write_b128 v4, v[28:31] offset:1536
v_lshlrev_b32 v56, 16, v216
v_and_b32 v57, 0xffff0000, v216
v_lshlrev_b32 v60, 16, v218
v_and_b32 v61, 0xffff0000, v218
v_lshlrev_b32 v58, 16, v217
v_and_b32 v59, 0xffff0000, v217
v_lshlrev_b32 v62, 16, v219
v_and_b32 v63, 0xffff0000, v219
v_mul_f32_e64 v60, -v60, v56
v_mul_f32_e64 v61, -v61, v57
v_mul_f32_e64 v62, -v62, v58
v_mul_f32_e64 v63, -v63, v59
s_waitcnt vmcnt(8)
v_cvt_f32_i32 v112, v112
v_cvt_f32_i32 v116, v116
v_cvt_f32_i32 v120, v120
v_cvt_f32_i32 v124, v124
v_cvt_f32_i32 v128, v128
v_cvt_f32_i32 v132, v132
v_cvt_f32_i32 v136, v136
s_bfe_u32 s89, s96, 262164
s_mul_i32 s90, s89, 917504
s_add_u32 s20, s86, s90
s_addc_u32 s21, s87, 0
s_sub_u32 s22, s88, s90
buffer_load_dwordx4 v[176:179], v1, s[20:23], s32 offen
v_cvt_f32_i32 v140, v140
v_fma_f32 v112, v112, v48, v52
v_fma_f32 v116, v116, v48, v52
v_fma_f32 v120, v120, v48, v52
v_fma_f32 v124, v124, v48, v52
v_fma_f32 v128, v128, v48, v52
v_fma_f32 v132, v132, v48, v52
v_fma_f32 v136, v136, v48, v52
v_fma_f32 v140, v140, v48, v52
v_mul_f32_dpp v112, v33, v112 row_newbcast:8 row_mask:0xf bank_mask:0xf
v_mul_f32_dpp v116, v33, v116 row_newbcast:9 row_mask:0xf bank_mask:0xf
v_mul_f32_dpp v120, v33, v120 row_newbcast:10 row_mask:0xf bank_mask:0xf
v_mul_f32_dpp v124, v33, v124 row_newbcast:11 row_mask:0xf bank_mask:0xf
v_mul_f32_dpp v128, v33, v128 row_newbcast:12 row_mask:0xf bank_mask:0xf
buffer_load_dwordx4 v[180:183], v1, s[20:23], s33 offen
v_mul_f32_dpp v132, v33, v132 row_newbcast:13 row_mask:0xf bank_mask:0xf
v_mul_f32_dpp v136, v33, v136 row_newbcast:14 row_mask:0xf bank_mask:0xf
v_mul_f32_dpp v140, v33, v140 row_newbcast:15 row_mask:0xf bank_mask:0xf
v_cvt_pk_bf16_f32 v16, v112, v116
v_cvt_pk_bf16_f32 v17, v120, v124
v_cvt_pk_bf16_f32 v18, v128, v132
v_cvt_pk_bf16_f32 v19, v136, v140
s_waitcnt lgkmcnt(0)
s_barrier
ds_write_b128 v4, v[16:19] offset:16384
v_cvt_f32_i32 v113, v113
v_cvt_f32_i32 v117, v117
v_cvt_f32_i32 v121, v121
v_cvt_f32_i32 v125, v125
v_cvt_f32_i32 v129, v129
v_cvt_f32_i32 v133, v133
v_cvt_f32_i32 v137, v137
buffer_load_dwordx4 v[184:187], v1, s[20:23], s34 offen
v_cvt_f32_i32 v141, v141
v_fma_f32 v113, v113, v49, v53
v_fma_f32 v117, v117, v49, v53
v_fma_f32 v121, v121, v49, v53
v_fma_f32 v125, v125, v49, v53
v_fma_f32 v129, v129, v49, v53
v_fma_f32 v133, v133, v49, v53
v_fma_f32 v137, v137, v49, v53
v_fma_f32 v141, v141, v49, v53
v_mul_f32_dpp v113, v33, v113 row_newbcast:8 row_mask:0xf bank_mask:0xf
v_mul_f32_dpp v117, v33, v117 row_newbcast:9 row_mask:0xf bank_mask:0xf
v_mul_f32_dpp v121, v33, v121 row_newbcast:10 row_mask:0xf bank_mask:0xf
v_mul_f32_dpp v125, v33, v125 row_newbcast:11 row_mask:0xf bank_mask:0xf
v_mul_f32_dpp v129, v33, v129 row_newbcast:12 row_mask:0xf bank_mask:0xf
buffer_load_dwordx4 v[188:191], v1, s[20:23], s35 offen
v_mul_f32_dpp v133, v33, v133 row_newbcast:13 row_mask:0xf bank_mask:0xf
v_mul_f32_dpp v137, v33, v137 row_newbcast:14 row_mask:0xf bank_mask:0xf
v_mul_f32_dpp v141, v33, v141 row_newbcast:15 row_mask:0xf bank_mask:0xf
v_cvt_pk_bf16_f32 v20, v113, v117
v_cvt_pk_bf16_f32 v21, v121, v125
v_cvt_pk_bf16_f32 v22, v129, v133
v_cvt_pk_bf16_f32 v23, v137, v141
ds_write_b128 v4, v[20:23] offset:16896
v_cvt_f32_i32 v114, v114
v_cvt_f32_i32 v118, v118
v_cvt_f32_i32 v122, v122
v_cvt_f32_i32 v126, v126
v_cvt_f32_i32 v130, v130
v_cvt_f32_i32 v134, v134
v_cvt_f32_i32 v138, v138
buffer_load_dwordx4 v[192:195], v1, s[20:23], s36 offen
v_cvt_f32_i32 v142, v142
v_fma_f32 v114, v114, v50, v54
v_fma_f32 v118, v118, v50, v54
v_fma_f32 v122, v122, v50, v54
v_fma_f32 v126, v126, v50, v54
v_fma_f32 v130, v130, v50, v54
v_fma_f32 v134, v134, v50, v54
v_fma_f32 v138, v138, v50, v54
v_fma_f32 v142, v142, v50, v54
v_mul_f32_dpp v114, v33, v114 row_newbcast:8 row_mask:0xf bank_mask:0xf
v_mul_f32_dpp v118, v33, v118 row_newbcast:9 row_mask:0xf bank_mask:0xf
v_mul_f32_dpp v122, v33, v122 row_newbcast:10 row_mask:0xf bank_mask:0xf
v_mul_f32_dpp v126, v33, v126 row_newbcast:11 row_mask:0xf bank_mask:0xf
v_mul_f32_dpp v130, v33, v130 row_newbcast:12 row_mask:0xf bank_mask:0xf
buffer_load_dwordx4 v[196:199], v1, s[20:23], s37 offen
v_mul_f32_dpp v134, v33, v134 row_newbcast:13 row_mask:0xf bank_mask:0xf
v_mul_f32_dpp v138, v33, v138 row_newbcast:14 row_mask:0xf bank_mask:0xf
v_mul_f32_dpp v142, v33, v142 row_newbcast:15 row_mask:0xf bank_mask:0xf
v_cvt_pk_bf16_f32 v24, v114, v118
v_cvt_pk_bf16_f32 v25, v122, v126
v_cvt_pk_bf16_f32 v26, v130, v134
v_cvt_pk_bf16_f32 v27, v138, v142
ds_write_b128 v4, v[24:27] offset:17408
v_cvt_f32_i32 v115, v115
v_cvt_f32_i32 v119, v119
v_cvt_f32_i32 v123, v123
v_cvt_f32_i32 v127, v127
v_cvt_f32_i32 v131, v131
v_cvt_f32_i32 v135, v135
v_cvt_f32_i32 v139, v139
buffer_load_dwordx4 v[200:203], v1, s[20:23], s38 offen
v_cvt_f32_i32 v143, v143
v_fma_f32 v115, v115, v51, v55
v_fma_f32 v119, v119, v51, v55
v_fma_f32 v123, v123, v51, v55
v_fma_f32 v127, v127, v51, v55
v_fma_f32 v131, v131, v51, v55
v_fma_f32 v135, v135, v51, v55
v_fma_f32 v139, v139, v51, v55
v_fma_f32 v143, v143, v51, v55
v_mul_f32_dpp v115, v33, v115 row_newbcast:8 row_mask:0xf bank_mask:0xf
v_mul_f32_dpp v119, v33, v119 row_newbcast:9 row_mask:0xf bank_mask:0xf
v_mul_f32_dpp v123, v33, v123 row_newbcast:10 row_mask:0xf bank_mask:0xf
v_mul_f32_dpp v127, v33, v127 row_newbcast:11 row_mask:0xf bank_mask:0xf
v_mul_f32_dpp v131, v33, v131 row_newbcast:12 row_mask:0xf bank_mask:0xf
buffer_load_dwordx4 v[204:207], v1, s[20:23], s39 offen
v_mul_f32_dpp v135, v33, v135 row_newbcast:13 row_mask:0xf bank_mask:0xf
v_mul_f32_dpp v139, v33, v139 row_newbcast:14 row_mask:0xf bank_mask:0xf
v_mul_f32_dpp v143, v33, v143 row_newbcast:15 row_mask:0xf bank_mask:0xf
v_cvt_pk_bf16_f32 v28, v115, v119
v_cvt_pk_bf16_f32 v29, v123, v127
v_cvt_pk_bf16_f32 v30, v131, v135
v_cvt_pk_bf16_f32 v31, v139, v143
ds_write_b128 v4, v[28:31] offset:17920
s_waitcnt vmcnt(8)
v_cvt_f32_i32 v144, v144
v_cvt_f32_i32 v148, v148
v_cvt_f32_i32 v152, v152
v_cvt_f32_i32 v156, v156
v_cvt_f32_i32 v160, v160
v_cvt_f32_i32 v164, v164
v_cvt_f32_i32 v168, v168
s_bfe_u32 s89, s96, 262168
s_mul_i32 s90, s89, 917504
s_add_u32 s20, s86, s90
s_addc_u32 s21, s87, 0
s_sub_u32 s22, s88, s90
buffer_load_dwordx4 v[112:115], v1, s[20:23], s32 offen
v_cvt_f32_i32 v172, v172
v_fma_f32 v144, v144, v56, v60
v_fma_f32 v148, v148, v56, v60
v_fma_f32 v152, v152, v56, v60
v_fma_f32 v156, v156, v56, v60
v_fma_f32 v160, v160, v56, v60
v_fma_f32 v164, v164, v56, v60
v_fma_f32 v168, v168, v56, v60
v_fma_f32 v172, v172, v56, v60
v_mul_f32_dpp v144, v34, v144 row_newbcast:0 row_mask:0xf bank_mask:0xf
v_mul_f32_dpp v148, v34, v148 row_newbcast:1 row_mask:0xf bank_mask:0xf
v_mul_f32_dpp v152, v34, v152 row_newbcast:2 row_mask:0xf bank_mask:0xf
v_mul_f32_dpp v156, v34, v156 row_newbcast:3 row_mask:0xf bank_mask:0xf
v_mul_f32_dpp v160, v34, v160 row_newbcast:4 row_mask:0xf bank_mask:0xf
buffer_load_dwordx4 v[116:119], v1, s[20:23], s33 offen
v_mul_f32_dpp v164, v34, v164 row_newbcast:5 row_mask:0xf bank_mask:0xf
v_mul_f32_dpp v168, v34, v168 row_newbcast:6 row_mask:0xf bank_mask:0xf
v_mul_f32_dpp v172, v34, v172 row_newbcast:7 row_mask:0xf bank_mask:0xf
v_cvt_pk_bf16_f32 v16, v144, v148
v_cvt_pk_bf16_f32 v17, v152, v156
v_cvt_pk_bf16_f32 v18, v160, v164
v_cvt_pk_bf16_f32 v19, v168, v172
s_waitcnt lgkmcnt(0)
s_barrier
ds_write_b128 v4, v[16:19] offset:0
v_cvt_f32_i32 v145, v145
v_cvt_f32_i32 v149, v149
v_cvt_f32_i32 v153, v153
v_cvt_f32_i32 v157, v157
v_cvt_f32_i32 v161, v161
v_cvt_f32_i32 v165, v165
v_cvt_f32_i32 v169, v169
buffer_load_dwordx4 v[120:123], v1, s[20:23], s34 offen
v_cvt_f32_i32 v173, v173
v_fma_f32 v145, v145, v57, v61
v_fma_f32 v149, v149, v57, v61
v_fma_f32 v153, v153, v57, v61
v_fma_f32 v157, v157, v57, v61
v_fma_f32 v161, v161, v57, v61
v_fma_f32 v165, v165, v57, v61
v_fma_f32 v169, v169, v57, v61
v_fma_f32 v173, v173, v57, v61
v_mul_f32_dpp v145, v34, v145 row_newbcast:0 row_mask:0xf bank_mask:0xf
v_mul_f32_dpp v149, v34, v149 row_newbcast:1 row_mask:0xf bank_mask:0xf
v_mul_f32_dpp v153, v34, v153 row_newbcast:2 row_mask:0xf bank_mask:0xf
v_mul_f32_dpp v157, v34, v157 row_newbcast:3 row_mask:0xf bank_mask:0xf
v_mul_f32_dpp v161, v34, v161 row_newbcast:4 row_mask:0xf bank_mask:0xf
buffer_load_dwordx4 v[124:127], v1, s[20:23], s35 offen
v_mul_f32_dpp v165, v34, v165 row_newbcast:5 row_mask:0xf bank_mask:0xf
v_mul_f32_dpp v169, v34, v169 row_newbcast:6 row_mask:0xf bank_mask:0xf
v_mul_f32_dpp v173, v34, v173 row_newbcast:7 row_mask:0xf bank_mask:0xf
v_cvt_pk_bf16_f32 v20, v145, v149
v_cvt_pk_bf16_f32 v21, v153, v157
v_cvt_pk_bf16_f32 v22, v161, v165
v_cvt_pk_bf16_f32 v23, v169, v173
ds_write_b128 v4, v[20:23] offset:512
v_cvt_f32_i32 v146, v146
v_cvt_f32_i32 v150, v150
v_cvt_f32_i32 v154, v154
v_cvt_f32_i32 v158, v158
v_cvt_f32_i32 v162, v162
v_cvt_f32_i32 v166, v166
v_cvt_f32_i32 v170, v170
buffer_load_dwordx4 v[128:131], v1, s[20:23], s36 offen
v_cvt_f32_i32 v174, v174
v_fma_f32 v146, v146, v58, v62
v_fma_f32 v150, v150, v58, v62
v_fma_f32 v154, v154, v58, v62
v_fma_f32 v158, v158, v58, v62
v_fma_f32 v162, v162, v58, v62
v_fma_f32 v166, v166, v58, v62
v_fma_f32 v170, v170, v58, v62
v_fma_f32 v174, v174, v58, v62
v_mul_f32_dpp v146, v34, v146 row_newbcast:0 row_mask:0xf bank_mask:0xf
v_mul_f32_dpp v150, v34, v150 row_newbcast:1 row_mask:0xf bank_mask:0xf
v_mul_f32_dpp v154, v34, v154 row_newbcast:2 row_mask:0xf bank_mask:0xf
v_mul_f32_dpp v158, v34, v158 row_newbcast:3 row_mask:0xf bank_mask:0xf
v_mul_f32_dpp v162, v34, v162 row_newbcast:4 row_mask:0xf bank_mask:0xf
buffer_load_dwordx4 v[132:135], v1, s[20:23], s37 offen
v_mul_f32_dpp v166, v34, v166 row_newbcast:5 row_mask:0xf bank_mask:0xf
v_mul_f32_dpp v170, v34, v170 row_newbcast:6 row_mask:0xf bank_mask:0xf
v_mul_f32_dpp v174, v34, v174 row_newbcast:7 row_mask:0xf bank_mask:0xf
v_cvt_pk_bf16_f32 v24, v146, v150
v_cvt_pk_bf16_f32 v25, v154, v158
v_cvt_pk_bf16_f32 v26, v162, v166
v_cvt_pk_bf16_f32 v27, v170, v174
ds_write_b128 v4, v[24:27] offset:1024
v_cvt_f32_i32 v147, v147
v_cvt_f32_i32 v151, v151
v_cvt_f32_i32 v155, v155
v_cvt_f32_i32 v159, v159
v_cvt_f32_i32 v163, v163
v_cvt_f32_i32 v167, v167
v_cvt_f32_i32 v171, v171
buffer_load_dwordx4 v[136:139], v1, s[20:23], s38 offen
v_cvt_f32_i32 v175, v175
v_fma_f32 v147, v147, v59, v63
v_fma_f32 v151, v151, v59, v63
v_fma_f32 v155, v155, v59, v63
v_fma_f32 v159, v159, v59, v63
v_fma_f32 v163, v163, v59, v63
v_fma_f32 v167, v167, v59, v63
v_fma_f32 v171, v171, v59, v63
v_fma_f32 v175, v175, v59, v63
v_mul_f32_dpp v147, v34, v147 row_newbcast:0 row_mask:0xf bank_mask:0xf
v_mul_f32_dpp v151, v34, v151 row_newbcast:1 row_mask:0xf bank_mask:0xf
v_mul_f32_dpp v155, v34, v155 row_newbcast:2 row_mask:0xf bank_mask:0xf
v_mul_f32_dpp v159, v34, v159 row_newbcast:3 row_mask:0xf bank_mask:0xf
v_mul_f32_dpp v163, v34, v163 row_newbcast:4 row_mask:0xf bank_mask:0xf
buffer_load_dwordx4 v[140:143], v1, s[20:23], s39 offen
v_mul_f32_dpp v167, v34, v167 row_newbcast:5 row_mask:0xf bank_mask:0xf
v_mul_f32_dpp v171, v34, v171 row_newbcast:6 row_mask:0xf bank_mask:0xf
v_mul_f32_dpp v175, v34, v175 row_newbcast:7 row_mask:0xf bank_mask:0xf
v_cvt_pk_bf16_f32 v28, v147, v151
v_cvt_pk_bf16_f32 v29, v155, v159
v_cvt_pk_bf16_f32 v30, v163, v167
v_cvt_pk_bf16_f32 v31, v171, v175
ds_write_b128 v4, v[28:31] offset:1536
v_lshlrev_b32 v64, 16, v220
v_and_b32 v65, 0xffff0000, v220
v_lshlrev_b32 v68, 16, v222
v_and_b32 v69, 0xffff0000, v222
v_lshlrev_b32 v66, 16, v221
v_and_b32 v67, 0xffff0000, v221
v_lshlrev_b32 v70, 16, v223
v_and_b32 v71, 0xffff0000, v223
v_mul_f32_e64 v68, -v68, v64
v_mul_f32_e64 v69, -v69, v65
v_mul_f32_e64 v70, -v70, v66
v_mul_f32_e64 v71, -v71, v67
s_waitcnt vmcnt(8)
v_cvt_f32_i32 v176, v176
v_cvt_f32_i32 v180, v180
v_cvt_f32_i32 v184, v184
v_cvt_f32_i32 v188, v188
v_cvt_f32_i32 v192, v192
v_cvt_f32_i32 v196, v196
v_cvt_f32_i32 v200, v200
s_bfe_u32 s89, s96, 262172
s_mul_i32 s90, s89, 917504
s_add_u32 s20, s86, s90
s_addc_u32 s21, s87, 0
s_sub_u32 s22, s88, s90
buffer_load_dwordx4 v[144:147], v1, s[20:23], s32 offen
v_cvt_f32_i32 v204, v204
v_fma_f32 v176, v176, v56, v60
v_fma_f32 v180, v180, v56, v60
v_fma_f32 v184, v184, v56, v60
v_fma_f32 v188, v188, v56, v60
v_fma_f32 v192, v192, v56, v60
v_fma_f32 v196, v196, v56, v60
v_fma_f32 v200, v200, v56, v60
v_fma_f32 v204, v204, v56, v60
v_mul_f32_dpp v176, v34, v176 row_newbcast:8 row_mask:0xf bank_mask:0xf
v_mul_f32_dpp v180, v34, v180 row_newbcast:9 row_mask:0xf bank_mask:0xf
v_mul_f32_dpp v184, v34, v184 row_newbcast:10 row_mask:0xf bank_mask:0xf
v_mul_f32_dpp v188, v34, v188 row_newbcast:11 row_mask:0xf bank_mask:0xf
v_mul_f32_dpp v192, v34, v192 row_newbcast:12 row_mask:0xf bank_mask:0xf
buffer_load_dwordx4 v[148:151], v1, s[20:23], s33 offen
v_mul_f32_dpp v196, v34, v196 row_newbcast:13 row_mask:0xf bank_mask:0xf
v_mul_f32_dpp v200, v34, v200 row_newbcast:14 row_mask:0xf bank_mask:0xf
v_mul_f32_dpp v204, v34, v204 row_newbcast:15 row_mask:0xf bank_mask:0xf
v_cvt_pk_bf16_f32 v16, v176, v180
v_cvt_pk_bf16_f32 v17, v184, v188
v_cvt_pk_bf16_f32 v18, v192, v196
v_cvt_pk_bf16_f32 v19, v200, v204
s_waitcnt lgkmcnt(0)
s_barrier
ds_write_b128 v4, v[16:19] offset:16384
v_cvt_f32_i32 v177, v177
v_cvt_f32_i32 v181, v181
v_cvt_f32_i32 v185, v185
v_cvt_f32_i32 v189, v189
v_cvt_f32_i32 v193, v193
v_cvt_f32_i32 v197, v197
v_cvt_f32_i32 v201, v201
buffer_load_dwordx4 v[152:155], v1, s[20:23], s34 offen
v_cvt_f32_i32 v205, v205
v_fma_f32 v177, v177, v57, v61
v_fma_f32 v181, v181, v57, v61
v_fma_f32 v185, v185, v57, v61
v_fma_f32 v189, v189, v57, v61
v_fma_f32 v193, v193, v57, v61
v_fma_f32 v197, v197, v57, v61
v_fma_f32 v201, v201, v57, v61
v_fma_f32 v205, v205, v57, v61
v_mul_f32_dpp v177, v34, v177 row_newbcast:8 row_mask:0xf bank_mask:0xf
v_mul_f32_dpp v181, v34, v181 row_newbcast:9 row_mask:0xf bank_mask:0xf
v_mul_f32_dpp v185, v34, v185 row_newbcast:10 row_mask:0xf bank_mask:0xf
v_mul_f32_dpp v189, v34, v189 row_newbcast:11 row_mask:0xf bank_mask:0xf
v_mul_f32_dpp v193, v34, v193 row_newbcast:12 row_mask:0xf bank_mask:0xf
buffer_load_dwordx4 v[156:159], v1, s[20:23], s35 offen
v_mul_f32_dpp v197, v34, v197 row_newbcast:13 row_mask:0xf bank_mask:0xf
v_mul_f32_dpp v201, v34, v201 row_newbcast:14 row_mask:0xf bank_mask:0xf
v_mul_f32_dpp v205, v34, v205 row_newbcast:15 row_mask:0xf bank_mask:0xf
v_cvt_pk_bf16_f32 v20, v177, v181
v_cvt_pk_bf16_f32 v21, v185, v189
v_cvt_pk_bf16_f32 v22, v193, v197
v_cvt_pk_bf16_f32 v23, v201, v205
ds_write_b128 v4, v[20:23] offset:16896
v_cvt_f32_i32 v178, v178
v_cvt_f32_i32 v182, v182
v_cvt_f32_i32 v186, v186
v_cvt_f32_i32 v190, v190
v_cvt_f32_i32 v194, v194
v_cvt_f32_i32 v198, v198
v_cvt_f32_i32 v202, v202
buffer_load_dwordx4 v[160:163], v1, s[20:23], s36 offen
v_cvt_f32_i32 v206, v206
v_fma_f32 v178, v178, v58, v62
v_fma_f32 v182, v182, v58, v62
v_fma_f32 v186, v186, v58, v62
v_fma_f32 v190, v190, v58, v62
v_fma_f32 v194, v194, v58, v62
v_fma_f32 v198, v198, v58, v62
v_fma_f32 v202, v202, v58, v62
v_fma_f32 v206, v206, v58, v62
v_mul_f32_dpp v178, v34, v178 row_newbcast:8 row_mask:0xf bank_mask:0xf
v_mul_f32_dpp v182, v34, v182 row_newbcast:9 row_mask:0xf bank_mask:0xf
v_mul_f32_dpp v186, v34, v186 row_newbcast:10 row_mask:0xf bank_mask:0xf
v_mul_f32_dpp v190, v34, v190 row_newbcast:11 row_mask:0xf bank_mask:0xf
v_mul_f32_dpp v194, v34, v194 row_newbcast:12 row_mask:0xf bank_mask:0xf
buffer_load_dwordx4 v[164:167], v1, s[20:23], s37 offen
v_mul_f32_dpp v198, v34, v198 row_newbcast:13 row_mask:0xf bank_mask:0xf
v_mul_f32_dpp v202, v34, v202 row_newbcast:14 row_mask:0xf bank_mask:0xf
v_mul_f32_dpp v206, v34, v206 row_newbcast:15 row_mask:0xf bank_mask:0xf
v_cvt_pk_bf16_f32 v24, v178, v182
v_cvt_pk_bf16_f32 v25, v186, v190
v_cvt_pk_bf16_f32 v26, v194, v198
v_cvt_pk_bf16_f32 v27, v202, v206
ds_write_b128 v4, v[24:27] offset:17408
v_cvt_f32_i32 v179, v179
v_cvt_f32_i32 v183, v183
v_cvt_f32_i32 v187, v187
v_cvt_f32_i32 v191, v191
v_cvt_f32_i32 v195, v195
v_cvt_f32_i32 v199, v199
v_cvt_f32_i32 v203, v203
buffer_load_dwordx4 v[168:171], v1, s[20:23], s38 offen
v_cvt_f32_i32 v207, v207
v_fma_f32 v179, v179, v59, v63
v_fma_f32 v183, v183, v59, v63
v_fma_f32 v187, v187, v59, v63
v_fma_f32 v191, v191, v59, v63
v_fma_f32 v195, v195, v59, v63
v_fma_f32 v199, v199, v59, v63
v_fma_f32 v203, v203, v59, v63
v_fma_f32 v207, v207, v59, v63
v_mul_f32_dpp v179, v34, v179 row_newbcast:8 row_mask:0xf bank_mask:0xf
v_mul_f32_dpp v183, v34, v183 row_newbcast:9 row_mask:0xf bank_mask:0xf
v_mul_f32_dpp v187, v34, v187 row_newbcast:10 row_mask:0xf bank_mask:0xf
v_mul_f32_dpp v191, v34, v191 row_newbcast:11 row_mask:0xf bank_mask:0xf
v_mul_f32_dpp v195, v34, v195 row_newbcast:12 row_mask:0xf bank_mask:0xf
buffer_load_dwordx4 v[172:175], v1, s[20:23], s39 offen
v_mul_f32_dpp v199, v34, v199 row_newbcast:13 row_mask:0xf bank_mask:0xf
v_mul_f32_dpp v203, v34, v203 row_newbcast:14 row_mask:0xf bank_mask:0xf
v_mul_f32_dpp v207, v34, v207 row_newbcast:15 row_mask:0xf bank_mask:0xf
v_cvt_pk_bf16_f32 v28, v179, v183
v_cvt_pk_bf16_f32 v29, v187, v191
v_cvt_pk_bf16_f32 v30, v195, v199
v_cvt_pk_bf16_f32 v31, v203, v207
ds_write_b128 v4, v[28:31] offset:17920
s_waitcnt vmcnt(8)
v_cvt_f32_i32 v112, v112
v_cvt_f32_i32 v116, v116
v_cvt_f32_i32 v120, v120
v_cvt_f32_i32 v124, v124
v_cvt_f32_i32 v128, v128
v_cvt_f32_i32 v132, v132
v_cvt_f32_i32 v136, v136
s_bfe_u32 s89, s97, 262144
s_mul_i32 s90, s89, 917504
s_add_u32 s20, s86, s90
s_addc_u32 s21, s87, 0
s_sub_u32 s22, s88, s90
buffer_load_dwordx4 v[176:179], v1, s[20:23], s32 offen
v_cvt_f32_i32 v140, v140
v_fma_f32 v112, v112, v64, v68
v_fma_f32 v116, v116, v64, v68
v_fma_f32 v120, v120, v64, v68
v_fma_f32 v124, v124, v64, v68
v_fma_f32 v128, v128, v64, v68
v_fma_f32 v132, v132, v64, v68
v_fma_f32 v136, v136, v64, v68
v_fma_f32 v140, v140, v64, v68
v_mul_f32_dpp v112, v35, v112 row_newbcast:0 row_mask:0xf bank_mask:0xf
v_mul_f32_dpp v116, v35, v116 row_newbcast:1 row_mask:0xf bank_mask:0xf
v_mul_f32_dpp v120, v35, v120 row_newbcast:2 row_mask:0xf bank_mask:0xf
v_mul_f32_dpp v124, v35, v124 row_newbcast:3 row_mask:0xf bank_mask:0xf
v_mul_f32_dpp v128, v35, v128 row_newbcast:4 row_mask:0xf bank_mask:0xf
buffer_load_dwordx4 v[180:183], v1, s[20:23], s33 offen
v_mul_f32_dpp v132, v35, v132 row_newbcast:5 row_mask:0xf bank_mask:0xf
v_mul_f32_dpp v136, v35, v136 row_newbcast:6 row_mask:0xf bank_mask:0xf
v_mul_f32_dpp v140, v35, v140 row_newbcast:7 row_mask:0xf bank_mask:0xf
v_cvt_pk_bf16_f32 v16, v112, v116
v_cvt_pk_bf16_f32 v17, v120, v124
v_cvt_pk_bf16_f32 v18, v128, v132
v_cvt_pk_bf16_f32 v19, v136, v140
s_waitcnt lgkmcnt(0)
s_barrier
ds_write_b128 v4, v[16:19] offset:0
v_cvt_f32_i32 v113, v113
v_cvt_f32_i32 v117, v117
v_cvt_f32_i32 v121, v121
v_cvt_f32_i32 v125, v125
v_cvt_f32_i32 v129, v129
v_cvt_f32_i32 v133, v133
v_cvt_f32_i32 v137, v137
buffer_load_dwordx4 v[184:187], v1, s[20:23], s34 offen
v_cvt_f32_i32 v141, v141
v_fma_f32 v113, v113, v65, v69
v_fma_f32 v117, v117, v65, v69
v_fma_f32 v121, v121, v65, v69
v_fma_f32 v125, v125, v65, v69
v_fma_f32 v129, v129, v65, v69
v_fma_f32 v133, v133, v65, v69
v_fma_f32 v137, v137, v65, v69
v_fma_f32 v141, v141, v65, v69
v_mul_f32_dpp v113, v35, v113 row_newbcast:0 row_mask:0xf bank_mask:0xf
v_mul_f32_dpp v117, v35, v117 row_newbcast:1 row_mask:0xf bank_mask:0xf
v_mul_f32_dpp v121, v35, v121 row_newbcast:2 row_mask:0xf bank_mask:0xf
v_mul_f32_dpp v125, v35, v125 row_newbcast:3 row_mask:0xf bank_mask:0xf
v_mul_f32_dpp v129, v35, v129 row_newbcast:4 row_mask:0xf bank_mask:0xf
buffer_load_dwordx4 v[188:191], v1, s[20:23], s35 offen
v_mul_f32_dpp v133, v35, v133 row_newbcast:5 row_mask:0xf bank_mask:0xf
v_mul_f32_dpp v137, v35, v137 row_newbcast:6 row_mask:0xf bank_mask:0xf
v_mul_f32_dpp v141, v35, v141 row_newbcast:7 row_mask:0xf bank_mask:0xf
v_cvt_pk_bf16_f32 v20, v113, v117
v_cvt_pk_bf16_f32 v21, v121, v125
v_cvt_pk_bf16_f32 v22, v129, v133
v_cvt_pk_bf16_f32 v23, v137, v141
ds_write_b128 v4, v[20:23] offset:512
v_cvt_f32_i32 v114, v114
v_cvt_f32_i32 v118, v118
v_cvt_f32_i32 v122, v122
v_cvt_f32_i32 v126, v126
v_cvt_f32_i32 v130, v130
v_cvt_f32_i32 v134, v134
v_cvt_f32_i32 v138, v138
buffer_load_dwordx4 v[192:195], v1, s[20:23], s36 offen
v_cvt_f32_i32 v142, v142
v_fma_f32 v114, v114, v66, v70
v_fma_f32 v118, v118, v66, v70
v_fma_f32 v122, v122, v66, v70
v_fma_f32 v126, v126, v66, v70
v_fma_f32 v130, v130, v66, v70
v_fma_f32 v134, v134, v66, v70
v_fma_f32 v138, v138, v66, v70
v_fma_f32 v142, v142, v66, v70
v_mul_f32_dpp v114, v35, v114 row_newbcast:0 row_mask:0xf bank_mask:0xf
v_mul_f32_dpp v118, v35, v118 row_newbcast:1 row_mask:0xf bank_mask:0xf
v_mul_f32_dpp v122, v35, v122 row_newbcast:2 row_mask:0xf bank_mask:0xf
v_mul_f32_dpp v126, v35, v126 row_newbcast:3 row_mask:0xf bank_mask:0xf
v_mul_f32_dpp v130, v35, v130 row_newbcast:4 row_mask:0xf bank_mask:0xf
buffer_load_dwordx4 v[196:199], v1, s[20:23], s37 offen
v_mul_f32_dpp v134, v35, v134 row_newbcast:5 row_mask:0xf bank_mask:0xf
v_mul_f32_dpp v138, v35, v138 row_newbcast:6 row_mask:0xf bank_mask:0xf
v_mul_f32_dpp v142, v35, v142 row_newbcast:7 row_mask:0xf bank_mask:0xf
v_cvt_pk_bf16_f32 v24, v114, v118
v_cvt_pk_bf16_f32 v25, v122, v126
v_cvt_pk_bf16_f32 v26, v130, v134
v_cvt_pk_bf16_f32 v27, v138, v142
ds_write_b128 v4, v[24:27] offset:1024
v_cvt_f32_i32 v115, v115
v_cvt_f32_i32 v119, v119
v_cvt_f32_i32 v123, v123
v_cvt_f32_i32 v127, v127
v_cvt_f32_i32 v131, v131
v_cvt_f32_i32 v135, v135
v_cvt_f32_i32 v139, v139
buffer_load_dwordx4 v[200:203], v1, s[20:23], s38 offen
v_cvt_f32_i32 v143, v143
v_fma_f32 v115, v115, v67, v71
v_fma_f32 v119, v119, v67, v71
v_fma_f32 v123, v123, v67, v71
v_fma_f32 v127, v127, v67, v71
v_fma_f32 v131, v131, v67, v71
v_fma_f32 v135, v135, v67, v71
v_fma_f32 v139, v139, v67, v71
v_fma_f32 v143, v143, v67, v71
v_mul_f32_dpp v115, v35, v115 row_newbcast:0 row_mask:0xf bank_mask:0xf
v_mul_f32_dpp v119, v35, v119 row_newbcast:1 row_mask:0xf bank_mask:0xf
v_mul_f32_dpp v123, v35, v123 row_newbcast:2 row_mask:0xf bank_mask:0xf
v_mul_f32_dpp v127, v35, v127 row_newbcast:3 row_mask:0xf bank_mask:0xf
v_mul_f32_dpp v131, v35, v131 row_newbcast:4 row_mask:0xf bank_mask:0xf
buffer_load_dwordx4 v[204:207], v1, s[20:23], s39 offen
v_mul_f32_dpp v135, v35, v135 row_newbcast:5 row_mask:0xf bank_mask:0xf
v_mul_f32_dpp v139, v35, v139 row_newbcast:6 row_mask:0xf bank_mask:0xf
v_mul_f32_dpp v143, v35, v143 row_newbcast:7 row_mask:0xf bank_mask:0xf
v_cvt_pk_bf16_f32 v28, v115, v119
v_cvt_pk_bf16_f32 v29, v123, v127
v_cvt_pk_bf16_f32 v30, v131, v135
v_cvt_pk_bf16_f32 v31, v139, v143
ds_write_b128 v4, v[28:31] offset:1536
v_lshlrev_b32 v72, 16, v224
v_and_b32 v73, 0xffff0000, v224
v_lshlrev_b32 v76, 16, v226
v_and_b32 v77, 0xffff0000, v226
v_lshlrev_b32 v74, 16, v225
v_and_b32 v75, 0xffff0000, v225
v_lshlrev_b32 v78, 16, v227
v_and_b32 v79, 0xffff0000, v227
v_mul_f32_e64 v76, -v76, v72
v_mul_f32_e64 v77, -v77, v73
v_mul_f32_e64 v78, -v78, v74
v_mul_f32_e64 v79, -v79, v75
s_waitcnt vmcnt(8)
v_cvt_f32_i32 v144, v144
v_cvt_f32_i32 v148, v148
v_cvt_f32_i32 v152, v152
v_cvt_f32_i32 v156, v156
v_cvt_f32_i32 v160, v160
v_cvt_f32_i32 v164, v164
v_cvt_f32_i32 v168, v168
s_bfe_u32 s89, s97, 262148
s_mul_i32 s90, s89, 917504
s_add_u32 s20, s86, s90
s_addc_u32 s21, s87, 0
s_sub_u32 s22, s88, s90
buffer_load_dwordx4 v[112:115], v1, s[20:23], s32 offen
v_cvt_f32_i32 v172, v172
v_fma_f32 v144, v144, v64, v68
v_fma_f32 v148, v148, v64, v68
v_fma_f32 v152, v152, v64, v68
v_fma_f32 v156, v156, v64, v68
v_fma_f32 v160, v160, v64, v68
v_fma_f32 v164, v164, v64, v68
v_fma_f32 v168, v168, v64, v68
v_fma_f32 v172, v172, v64, v68
v_mul_f32_dpp v144, v35, v144 row_newbcast:8 row_mask:0xf bank_mask:0xf
v_mul_f32_dpp v148, v35, v148 row_newbcast:9 row_mask:0xf bank_mask:0xf
v_mul_f32_dpp v152, v35, v152 row_newbcast:10 row_mask:0xf bank_mask:0xf
v_mul_f32_dpp v156, v35, v156 row_newbcast:11 row_mask:0xf bank_mask:0xf
v_mul_f32_dpp v160, v35, v160 row_newbcast:12 row_mask:0xf bank_mask:0xf
buffer_load_dwordx4 v[116:119], v1, s[20:23], s33 offen
v_mul_f32_dpp v164, v35, v164 row_newbcast:13 row_mask:0xf bank_mask:0xf
v_mul_f32_dpp v168, v35, v168 row_newbcast:14 row_mask:0xf bank_mask:0xf
v_mul_f32_dpp v172, v35, v172 row_newbcast:15 row_mask:0xf bank_mask:0xf
v_cvt_pk_bf16_f32 v16, v144, v148
v_cvt_pk_bf16_f32 v17, v152, v156
v_cvt_pk_bf16_f32 v18, v160, v164
v_cvt_pk_bf16_f32 v19, v168, v172
s_waitcnt lgkmcnt(0)
s_barrier
ds_write_b128 v4, v[16:19] offset:16384
v_cvt_f32_i32 v145, v145
v_cvt_f32_i32 v149, v149
v_cvt_f32_i32 v153, v153
v_cvt_f32_i32 v157, v157
v_cvt_f32_i32 v161, v161
v_cvt_f32_i32 v165, v165
v_cvt_f32_i32 v169, v169
buffer_load_dwordx4 v[120:123], v1, s[20:23], s34 offen
v_cvt_f32_i32 v173, v173
v_fma_f32 v145, v145, v65, v69
v_fma_f32 v149, v149, v65, v69
v_fma_f32 v153, v153, v65, v69
v_fma_f32 v157, v157, v65, v69
v_fma_f32 v161, v161, v65, v69
v_fma_f32 v165, v165, v65, v69
v_fma_f32 v169, v169, v65, v69
v_fma_f32 v173, v173, v65, v69
v_mul_f32_dpp v145, v35, v145 row_newbcast:8 row_mask:0xf bank_mask:0xf
v_mul_f32_dpp v149, v35, v149 row_newbcast:9 row_mask:0xf bank_mask:0xf
v_mul_f32_dpp v153, v35, v153 row_newbcast:10 row_mask:0xf bank_mask:0xf
v_mul_f32_dpp v157, v35, v157 row_newbcast:11 row_mask:0xf bank_mask:0xf
v_mul_f32_dpp v161, v35, v161 row_newbcast:12 row_mask:0xf bank_mask:0xf
buffer_load_dwordx4 v[124:127], v1, s[20:23], s35 offen
v_mul_f32_dpp v165, v35, v165 row_newbcast:13 row_mask:0xf bank_mask:0xf
v_mul_f32_dpp v169, v35, v169 row_newbcast:14 row_mask:0xf bank_mask:0xf
v_mul_f32_dpp v173, v35, v173 row_newbcast:15 row_mask:0xf bank_mask:0xf
v_cvt_pk_bf16_f32 v20, v145, v149
v_cvt_pk_bf16_f32 v21, v153, v157
v_cvt_pk_bf16_f32 v22, v161, v165
v_cvt_pk_bf16_f32 v23, v169, v173
ds_write_b128 v4, v[20:23] offset:16896
v_cvt_f32_i32 v146, v146
v_cvt_f32_i32 v150, v150
v_cvt_f32_i32 v154, v154
v_cvt_f32_i32 v158, v158
v_cvt_f32_i32 v162, v162
v_cvt_f32_i32 v166, v166
v_cvt_f32_i32 v170, v170
buffer_load_dwordx4 v[128:131], v1, s[20:23], s36 offen
v_cvt_f32_i32 v174, v174
v_fma_f32 v146, v146, v66, v70
v_fma_f32 v150, v150, v66, v70
v_fma_f32 v154, v154, v66, v70
v_fma_f32 v158, v158, v66, v70
v_fma_f32 v162, v162, v66, v70
v_fma_f32 v166, v166, v66, v70
v_fma_f32 v170, v170, v66, v70
v_fma_f32 v174, v174, v66, v70
v_mul_f32_dpp v146, v35, v146 row_newbcast:8 row_mask:0xf bank_mask:0xf
v_mul_f32_dpp v150, v35, v150 row_newbcast:9 row_mask:0xf bank_mask:0xf
v_mul_f32_dpp v154, v35, v154 row_newbcast:10 row_mask:0xf bank_mask:0xf
v_mul_f32_dpp v158, v35, v158 row_newbcast:11 row_mask:0xf bank_mask:0xf
v_mul_f32_dpp v162, v35, v162 row_newbcast:12 row_mask:0xf bank_mask:0xf
buffer_load_dwordx4 v[132:135], v1, s[20:23], s37 offen
v_mul_f32_dpp v166, v35, v166 row_newbcast:13 row_mask:0xf bank_mask:0xf
v_mul_f32_dpp v170, v35, v170 row_newbcast:14 row_mask:0xf bank_mask:0xf
v_mul_f32_dpp v174, v35, v174 row_newbcast:15 row_mask:0xf bank_mask:0xf
v_cvt_pk_bf16_f32 v24, v146, v150
v_cvt_pk_bf16_f32 v25, v154, v158
v_cvt_pk_bf16_f32 v26, v162, v166
v_cvt_pk_bf16_f32 v27, v170, v174
ds_write_b128 v4, v[24:27] offset:17408
v_cvt_f32_i32 v147, v147
v_cvt_f32_i32 v151, v151
v_cvt_f32_i32 v155, v155
v_cvt_f32_i32 v159, v159
v_cvt_f32_i32 v163, v163
v_cvt_f32_i32 v167, v167
v_cvt_f32_i32 v171, v171
buffer_load_dwordx4 v[136:139], v1, s[20:23], s38 offen
v_cvt_f32_i32 v175, v175
v_fma_f32 v147, v147, v67, v71
v_fma_f32 v151, v151, v67, v71
v_fma_f32 v155, v155, v67, v71
v_fma_f32 v159, v159, v67, v71
v_fma_f32 v163, v163, v67, v71
v_fma_f32 v167, v167, v67, v71
v_fma_f32 v171, v171, v67, v71
v_fma_f32 v175, v175, v67, v71
v_mul_f32_dpp v147, v35, v147 row_newbcast:8 row_mask:0xf bank_mask:0xf
v_mul_f32_dpp v151, v35, v151 row_newbcast:9 row_mask:0xf bank_mask:0xf
v_mul_f32_dpp v155, v35, v155 row_newbcast:10 row_mask:0xf bank_mask:0xf
v_mul_f32_dpp v159, v35, v159 row_newbcast:11 row_mask:0xf bank_mask:0xf
v_mul_f32_dpp v163, v35, v163 row_newbcast:12 row_mask:0xf bank_mask:0xf
buffer_load_dwordx4 v[140:143], v1, s[20:23], s39 offen
v_mul_f32_dpp v167, v35, v167 row_newbcast:13 row_mask:0xf bank_mask:0xf
v_mul_f32_dpp v171, v35, v171 row_newbcast:14 row_mask:0xf bank_mask:0xf
v_mul_f32_dpp v175, v35, v175 row_newbcast:15 row_mask:0xf bank_mask:0xf
v_cvt_pk_bf16_f32 v28, v147, v151
v_cvt_pk_bf16_f32 v29, v155, v159
v_cvt_pk_bf16_f32 v30, v163, v167
v_cvt_pk_bf16_f32 v31, v171, v175
ds_write_b128 v4, v[28:31] offset:17920
s_waitcnt vmcnt(8)
v_cvt_f32_i32 v176, v176
v_cvt_f32_i32 v180, v180
v_cvt_f32_i32 v184, v184
v_cvt_f32_i32 v188, v188
v_cvt_f32_i32 v192, v192
v_cvt_f32_i32 v196, v196
v_cvt_f32_i32 v200, v200
s_bfe_u32 s89, s97, 262152
s_mul_i32 s90, s89, 917504
s_add_u32 s20, s86, s90
s_addc_u32 s21, s87, 0
s_sub_u32 s22, s88, s90
buffer_load_dwordx4 v[144:147], v1, s[20:23], s32 offen
v_cvt_f32_i32 v204, v204
v_fma_f32 v176, v176, v72, v76
v_fma_f32 v180, v180, v72, v76
v_fma_f32 v184, v184, v72, v76
v_fma_f32 v188, v188, v72, v76
v_fma_f32 v192, v192, v72, v76
v_fma_f32 v196, v196, v72, v76
v_fma_f32 v200, v200, v72, v76
v_fma_f32 v204, v204, v72, v76
v_mul_f32_dpp v176, v36, v176 row_newbcast:0 row_mask:0xf bank_mask:0xf
v_mul_f32_dpp v180, v36, v180 row_newbcast:1 row_mask:0xf bank_mask:0xf
v_mul_f32_dpp v184, v36, v184 row_newbcast:2 row_mask:0xf bank_mask:0xf
v_mul_f32_dpp v188, v36, v188 row_newbcast:3 row_mask:0xf bank_mask:0xf
v_mul_f32_dpp v192, v36, v192 row_newbcast:4 row_mask:0xf bank_mask:0xf
buffer_load_dwordx4 v[148:151], v1, s[20:23], s33 offen
v_mul_f32_dpp v196, v36, v196 row_newbcast:5 row_mask:0xf bank_mask:0xf
v_mul_f32_dpp v200, v36, v200 row_newbcast:6 row_mask:0xf bank_mask:0xf
v_mul_f32_dpp v204, v36, v204 row_newbcast:7 row_mask:0xf bank_mask:0xf
v_cvt_pk_bf16_f32 v16, v176, v180
v_cvt_pk_bf16_f32 v17, v184, v188
v_cvt_pk_bf16_f32 v18, v192, v196
v_cvt_pk_bf16_f32 v19, v200, v204
s_waitcnt lgkmcnt(0)
s_barrier
ds_write_b128 v4, v[16:19] offset:0
v_cvt_f32_i32 v177, v177
v_cvt_f32_i32 v181, v181
v_cvt_f32_i32 v185, v185
v_cvt_f32_i32 v189, v189
v_cvt_f32_i32 v193, v193
v_cvt_f32_i32 v197, v197
v_cvt_f32_i32 v201, v201
buffer_load_dwordx4 v[152:155], v1, s[20:23], s34 offen
v_cvt_f32_i32 v205, v205
v_fma_f32 v177, v177, v73, v77
v_fma_f32 v181, v181, v73, v77
v_fma_f32 v185, v185, v73, v77
v_fma_f32 v189, v189, v73, v77
v_fma_f32 v193, v193, v73, v77
v_fma_f32 v197, v197, v73, v77
v_fma_f32 v201, v201, v73, v77
v_fma_f32 v205, v205, v73, v77
v_mul_f32_dpp v177, v36, v177 row_newbcast:0 row_mask:0xf bank_mask:0xf
v_mul_f32_dpp v181, v36, v181 row_newbcast:1 row_mask:0xf bank_mask:0xf
v_mul_f32_dpp v185, v36, v185 row_newbcast:2 row_mask:0xf bank_mask:0xf
v_mul_f32_dpp v189, v36, v189 row_newbcast:3 row_mask:0xf bank_mask:0xf
v_mul_f32_dpp v193, v36, v193 row_newbcast:4 row_mask:0xf bank_mask:0xf
buffer_load_dwordx4 v[156:159], v1, s[20:23], s35 offen
v_mul_f32_dpp v197, v36, v197 row_newbcast:5 row_mask:0xf bank_mask:0xf
v_mul_f32_dpp v201, v36, v201 row_newbcast:6 row_mask:0xf bank_mask:0xf
v_mul_f32_dpp v205, v36, v205 row_newbcast:7 row_mask:0xf bank_mask:0xf
v_cvt_pk_bf16_f32 v20, v177, v181
v_cvt_pk_bf16_f32 v21, v185, v189
v_cvt_pk_bf16_f32 v22, v193, v197
v_cvt_pk_bf16_f32 v23, v201, v205
ds_write_b128 v4, v[20:23] offset:512
v_cvt_f32_i32 v178, v178
v_cvt_f32_i32 v182, v182
v_cvt_f32_i32 v186, v186
v_cvt_f32_i32 v190, v190
v_cvt_f32_i32 v194, v194
v_cvt_f32_i32 v198, v198
v_cvt_f32_i32 v202, v202
buffer_load_dwordx4 v[160:163], v1, s[20:23], s36 offen
v_cvt_f32_i32 v206, v206
v_fma_f32 v178, v178, v74, v78
v_fma_f32 v182, v182, v74, v78
v_fma_f32 v186, v186, v74, v78
v_fma_f32 v190, v190, v74, v78
v_fma_f32 v194, v194, v74, v78
v_fma_f32 v198, v198, v74, v78
v_fma_f32 v202, v202, v74, v78
v_fma_f32 v206, v206, v74, v78
v_mul_f32_dpp v178, v36, v178 row_newbcast:0 row_mask:0xf bank_mask:0xf
v_mul_f32_dpp v182, v36, v182 row_newbcast:1 row_mask:0xf bank_mask:0xf
v_mul_f32_dpp v186, v36, v186 row_newbcast:2 row_mask:0xf bank_mask:0xf
v_mul_f32_dpp v190, v36, v190 row_newbcast:3 row_mask:0xf bank_mask:0xf
v_mul_f32_dpp v194, v36, v194 row_newbcast:4 row_mask:0xf bank_mask:0xf
buffer_load_dwordx4 v[164:167], v1, s[20:23], s37 offen
v_mul_f32_dpp v198, v36, v198 row_newbcast:5 row_mask:0xf bank_mask:0xf
v_mul_f32_dpp v202, v36, v202 row_newbcast:6 row_mask:0xf bank_mask:0xf
v_mul_f32_dpp v206, v36, v206 row_newbcast:7 row_mask:0xf bank_mask:0xf
v_cvt_pk_bf16_f32 v24, v178, v182
v_cvt_pk_bf16_f32 v25, v186, v190
v_cvt_pk_bf16_f32 v26, v194, v198
v_cvt_pk_bf16_f32 v27, v202, v206
ds_write_b128 v4, v[24:27] offset:1024
v_cvt_f32_i32 v179, v179
v_cvt_f32_i32 v183, v183
v_cvt_f32_i32 v187, v187
v_cvt_f32_i32 v191, v191
v_cvt_f32_i32 v195, v195
v_cvt_f32_i32 v199, v199
v_cvt_f32_i32 v203, v203
buffer_load_dwordx4 v[168:171], v1, s[20:23], s38 offen
v_cvt_f32_i32 v207, v207
v_fma_f32 v179, v179, v75, v79
v_fma_f32 v183, v183, v75, v79
v_fma_f32 v187, v187, v75, v79
v_fma_f32 v191, v191, v75, v79
v_fma_f32 v195, v195, v75, v79
v_fma_f32 v199, v199, v75, v79
v_fma_f32 v203, v203, v75, v79
v_fma_f32 v207, v207, v75, v79
v_mul_f32_dpp v179, v36, v179 row_newbcast:0 row_mask:0xf bank_mask:0xf
v_mul_f32_dpp v183, v36, v183 row_newbcast:1 row_mask:0xf bank_mask:0xf
v_mul_f32_dpp v187, v36, v187 row_newbcast:2 row_mask:0xf bank_mask:0xf
v_mul_f32_dpp v191, v36, v191 row_newbcast:3 row_mask:0xf bank_mask:0xf
v_mul_f32_dpp v195, v36, v195 row_newbcast:4 row_mask:0xf bank_mask:0xf
buffer_load_dwordx4 v[172:175], v1, s[20:23], s39 offen
v_mul_f32_dpp v199, v36, v199 row_newbcast:5 row_mask:0xf bank_mask:0xf
v_mul_f32_dpp v203, v36, v203 row_newbcast:6 row_mask:0xf bank_mask:0xf
v_mul_f32_dpp v207, v36, v207 row_newbcast:7 row_mask:0xf bank_mask:0xf
v_cvt_pk_bf16_f32 v28, v179, v183
v_cvt_pk_bf16_f32 v29, v187, v191
v_cvt_pk_bf16_f32 v30, v195, v199
v_cvt_pk_bf16_f32 v31, v203, v207
ds_write_b128 v4, v[28:31] offset:1536
v_lshlrev_b32 v80, 16, v228
v_and_b32 v81, 0xffff0000, v228
v_lshlrev_b32 v84, 16, v230
v_and_b32 v85, 0xffff0000, v230
v_lshlrev_b32 v82, 16, v229
v_and_b32 v83, 0xffff0000, v229
v_lshlrev_b32 v86, 16, v231
v_and_b32 v87, 0xffff0000, v231
v_mul_f32_e64 v84, -v84, v80
v_mul_f32_e64 v85, -v85, v81
v_mul_f32_e64 v86, -v86, v82
v_mul_f32_e64 v87, -v87, v83
s_waitcnt vmcnt(8)
v_cvt_f32_i32 v112, v112
v_cvt_f32_i32 v116, v116
v_cvt_f32_i32 v120, v120
v_cvt_f32_i32 v124, v124
v_cvt_f32_i32 v128, v128
v_cvt_f32_i32 v132, v132
v_cvt_f32_i32 v136, v136
s_bfe_u32 s89, s97, 262156
s_mul_i32 s90, s89, 917504
s_add_u32 s20, s86, s90
s_addc_u32 s21, s87, 0
s_sub_u32 s22, s88, s90
buffer_load_dwordx4 v[176:179], v1, s[20:23], s32 offen
v_cvt_f32_i32 v140, v140
v_fma_f32 v112, v112, v72, v76
v_fma_f32 v116, v116, v72, v76
v_fma_f32 v120, v120, v72, v76
v_fma_f32 v124, v124, v72, v76
v_fma_f32 v128, v128, v72, v76
v_fma_f32 v132, v132, v72, v76
v_fma_f32 v136, v136, v72, v76
v_fma_f32 v140, v140, v72, v76
v_mul_f32_dpp v112, v36, v112 row_newbcast:8 row_mask:0xf bank_mask:0xf
v_mul_f32_dpp v116, v36, v116 row_newbcast:9 row_mask:0xf bank_mask:0xf
v_mul_f32_dpp v120, v36, v120 row_newbcast:10 row_mask:0xf bank_mask:0xf
v_mul_f32_dpp v124, v36, v124 row_newbcast:11 row_mask:0xf bank_mask:0xf
v_mul_f32_dpp v128, v36, v128 row_newbcast:12 row_mask:0xf bank_mask:0xf
buffer_load_dwordx4 v[180:183], v1, s[20:23], s33 offen
v_mul_f32_dpp v132, v36, v132 row_newbcast:13 row_mask:0xf bank_mask:0xf
v_mul_f32_dpp v136, v36, v136 row_newbcast:14 row_mask:0xf bank_mask:0xf
v_mul_f32_dpp v140, v36, v140 row_newbcast:15 row_mask:0xf bank_mask:0xf
v_cvt_pk_bf16_f32 v16, v112, v116
v_cvt_pk_bf16_f32 v17, v120, v124
v_cvt_pk_bf16_f32 v18, v128, v132
v_cvt_pk_bf16_f32 v19, v136, v140
s_waitcnt lgkmcnt(0)
s_barrier
ds_write_b128 v4, v[16:19] offset:16384
v_cvt_f32_i32 v113, v113
v_cvt_f32_i32 v117, v117
v_cvt_f32_i32 v121, v121
v_cvt_f32_i32 v125, v125
v_cvt_f32_i32 v129, v129
v_cvt_f32_i32 v133, v133
v_cvt_f32_i32 v137, v137
buffer_load_dwordx4 v[184:187], v1, s[20:23], s34 offen
v_cvt_f32_i32 v141, v141
v_fma_f32 v113, v113, v73, v77
v_fma_f32 v117, v117, v73, v77
v_fma_f32 v121, v121, v73, v77
v_fma_f32 v125, v125, v73, v77
v_fma_f32 v129, v129, v73, v77
v_fma_f32 v133, v133, v73, v77
v_fma_f32 v137, v137, v73, v77
v_fma_f32 v141, v141, v73, v77
v_mul_f32_dpp v113, v36, v113 row_newbcast:8 row_mask:0xf bank_mask:0xf
v_mul_f32_dpp v117, v36, v117 row_newbcast:9 row_mask:0xf bank_mask:0xf
v_mul_f32_dpp v121, v36, v121 row_newbcast:10 row_mask:0xf bank_mask:0xf
v_mul_f32_dpp v125, v36, v125 row_newbcast:11 row_mask:0xf bank_mask:0xf
v_mul_f32_dpp v129, v36, v129 row_newbcast:12 row_mask:0xf bank_mask:0xf
buffer_load_dwordx4 v[188:191], v1, s[20:23], s35 offen
v_mul_f32_dpp v133, v36, v133 row_newbcast:13 row_mask:0xf bank_mask:0xf
v_mul_f32_dpp v137, v36, v137 row_newbcast:14 row_mask:0xf bank_mask:0xf
v_mul_f32_dpp v141, v36, v141 row_newbcast:15 row_mask:0xf bank_mask:0xf
v_cvt_pk_bf16_f32 v20, v113, v117
v_cvt_pk_bf16_f32 v21, v121, v125
v_cvt_pk_bf16_f32 v22, v129, v133
v_cvt_pk_bf16_f32 v23, v137, v141
ds_write_b128 v4, v[20:23] offset:16896
v_cvt_f32_i32 v114, v114
v_cvt_f32_i32 v118, v118
v_cvt_f32_i32 v122, v122
v_cvt_f32_i32 v126, v126
v_cvt_f32_i32 v130, v130
v_cvt_f32_i32 v134, v134
v_cvt_f32_i32 v138, v138
buffer_load_dwordx4 v[192:195], v1, s[20:23], s36 offen
v_cvt_f32_i32 v142, v142
v_fma_f32 v114, v114, v74, v78
v_fma_f32 v118, v118, v74, v78
v_fma_f32 v122, v122, v74, v78
v_fma_f32 v126, v126, v74, v78
v_fma_f32 v130, v130, v74, v78
v_fma_f32 v134, v134, v74, v78
v_fma_f32 v138, v138, v74, v78
v_fma_f32 v142, v142, v74, v78
v_mul_f32_dpp v114, v36, v114 row_newbcast:8 row_mask:0xf bank_mask:0xf
v_mul_f32_dpp v118, v36, v118 row_newbcast:9 row_mask:0xf bank_mask:0xf
v_mul_f32_dpp v122, v36, v122 row_newbcast:10 row_mask:0xf bank_mask:0xf
v_mul_f32_dpp v126, v36, v126 row_newbcast:11 row_mask:0xf bank_mask:0xf
v_mul_f32_dpp v130, v36, v130 row_newbcast:12 row_mask:0xf bank_mask:0xf
buffer_load_dwordx4 v[196:199], v1, s[20:23], s37 offen
v_mul_f32_dpp v134, v36, v134 row_newbcast:13 row_mask:0xf bank_mask:0xf
v_mul_f32_dpp v138, v36, v138 row_newbcast:14 row_mask:0xf bank_mask:0xf
v_mul_f32_dpp v142, v36, v142 row_newbcast:15 row_mask:0xf bank_mask:0xf
v_cvt_pk_bf16_f32 v24, v114, v118
v_cvt_pk_bf16_f32 v25, v122, v126
v_cvt_pk_bf16_f32 v26, v130, v134
v_cvt_pk_bf16_f32 v27, v138, v142
ds_write_b128 v4, v[24:27] offset:17408
v_cvt_f32_i32 v115, v115
v_cvt_f32_i32 v119, v119
v_cvt_f32_i32 v123, v123
v_cvt_f32_i32 v127, v127
v_cvt_f32_i32 v131, v131
v_cvt_f32_i32 v135, v135
v_cvt_f32_i32 v139, v139
buffer_load_dwordx4 v[200:203], v1, s[20:23], s38 offen
v_cvt_f32_i32 v143, v143
v_fma_f32 v115, v115, v75, v79
v_fma_f32 v119, v119, v75, v79
v_fma_f32 v123, v123, v75, v79
v_fma_f32 v127, v127, v75, v79
v_fma_f32 v131, v131, v75, v79
v_fma_f32 v135, v135, v75, v79
v_fma_f32 v139, v139, v75, v79
v_fma_f32 v143, v143, v75, v79
v_mul_f32_dpp v115, v36, v115 row_newbcast:8 row_mask:0xf bank_mask:0xf
v_mul_f32_dpp v119, v36, v119 row_newbcast:9 row_mask:0xf bank_mask:0xf
v_mul_f32_dpp v123, v36, v123 row_newbcast:10 row_mask:0xf bank_mask:0xf
v_mul_f32_dpp v127, v36, v127 row_newbcast:11 row_mask:0xf bank_mask:0xf
v_mul_f32_dpp v131, v36, v131 row_newbcast:12 row_mask:0xf bank_mask:0xf
buffer_load_dwordx4 v[204:207], v1, s[20:23], s39 offen
v_mul_f32_dpp v135, v36, v135 row_newbcast:13 row_mask:0xf bank_mask:0xf
v_mul_f32_dpp v139, v36, v139 row_newbcast:14 row_mask:0xf bank_mask:0xf
v_mul_f32_dpp v143, v36, v143 row_newbcast:15 row_mask:0xf bank_mask:0xf
v_cvt_pk_bf16_f32 v28, v115, v119
v_cvt_pk_bf16_f32 v29, v123, v127
v_cvt_pk_bf16_f32 v30, v131, v135
v_cvt_pk_bf16_f32 v31, v139, v143
ds_write_b128 v4, v[28:31] offset:17920
s_waitcnt vmcnt(8)
v_cvt_f32_i32 v144, v144
v_cvt_f32_i32 v148, v148
v_cvt_f32_i32 v152, v152
v_cvt_f32_i32 v156, v156
v_cvt_f32_i32 v160, v160
v_cvt_f32_i32 v164, v164
v_cvt_f32_i32 v168, v168
s_bfe_u32 s89, s97, 262160
s_mul_i32 s90, s89, 917504
s_add_u32 s20, s86, s90
s_addc_u32 s21, s87, 0
s_sub_u32 s22, s88, s90
buffer_load_dwordx4 v[112:115], v1, s[20:23], s32 offen
v_cvt_f32_i32 v172, v172
v_fma_f32 v144, v144, v80, v84
v_fma_f32 v148, v148, v80, v84
v_fma_f32 v152, v152, v80, v84
v_fma_f32 v156, v156, v80, v84
v_fma_f32 v160, v160, v80, v84
v_fma_f32 v164, v164, v80, v84
v_fma_f32 v168, v168, v80, v84
v_fma_f32 v172, v172, v80, v84
v_mul_f32_dpp v144, v37, v144 row_newbcast:0 row_mask:0xf bank_mask:0xf
v_mul_f32_dpp v148, v37, v148 row_newbcast:1 row_mask:0xf bank_mask:0xf
v_mul_f32_dpp v152, v37, v152 row_newbcast:2 row_mask:0xf bank_mask:0xf
v_mul_f32_dpp v156, v37, v156 row_newbcast:3 row_mask:0xf bank_mask:0xf
v_mul_f32_dpp v160, v37, v160 row_newbcast:4 row_mask:0xf bank_mask:0xf
buffer_load_dwordx4 v[116:119], v1, s[20:23], s33 offen
v_mul_f32_dpp v164, v37, v164 row_newbcast:5 row_mask:0xf bank_mask:0xf
v_mul_f32_dpp v168, v37, v168 row_newbcast:6 row_mask:0xf bank_mask:0xf
v_mul_f32_dpp v172, v37, v172 row_newbcast:7 row_mask:0xf bank_mask:0xf
v_cvt_pk_bf16_f32 v16, v144, v148
v_cvt_pk_bf16_f32 v17, v152, v156
v_cvt_pk_bf16_f32 v18, v160, v164
v_cvt_pk_bf16_f32 v19, v168, v172
s_waitcnt lgkmcnt(0)
s_barrier
ds_write_b128 v4, v[16:19] offset:0
v_cvt_f32_i32 v145, v145
v_cvt_f32_i32 v149, v149
v_cvt_f32_i32 v153, v153
v_cvt_f32_i32 v157, v157
v_cvt_f32_i32 v161, v161
v_cvt_f32_i32 v165, v165
v_cvt_f32_i32 v169, v169
buffer_load_dwordx4 v[120:123], v1, s[20:23], s34 offen
v_cvt_f32_i32 v173, v173
v_fma_f32 v145, v145, v81, v85
v_fma_f32 v149, v149, v81, v85
v_fma_f32 v153, v153, v81, v85
v_fma_f32 v157, v157, v81, v85
v_fma_f32 v161, v161, v81, v85
v_fma_f32 v165, v165, v81, v85
v_fma_f32 v169, v169, v81, v85
v_fma_f32 v173, v173, v81, v85
v_mul_f32_dpp v145, v37, v145 row_newbcast:0 row_mask:0xf bank_mask:0xf
v_mul_f32_dpp v149, v37, v149 row_newbcast:1 row_mask:0xf bank_mask:0xf
v_mul_f32_dpp v153, v37, v153 row_newbcast:2 row_mask:0xf bank_mask:0xf
v_mul_f32_dpp v157, v37, v157 row_newbcast:3 row_mask:0xf bank_mask:0xf
v_mul_f32_dpp v161, v37, v161 row_newbcast:4 row_mask:0xf bank_mask:0xf
buffer_load_dwordx4 v[124:127], v1, s[20:23], s35 offen
v_mul_f32_dpp v165, v37, v165 row_newbcast:5 row_mask:0xf bank_mask:0xf
v_mul_f32_dpp v169, v37, v169 row_newbcast:6 row_mask:0xf bank_mask:0xf
v_mul_f32_dpp v173, v37, v173 row_newbcast:7 row_mask:0xf bank_mask:0xf
v_cvt_pk_bf16_f32 v20, v145, v149
v_cvt_pk_bf16_f32 v21, v153, v157
v_cvt_pk_bf16_f32 v22, v161, v165
v_cvt_pk_bf16_f32 v23, v169, v173
ds_write_b128 v4, v[20:23] offset:512
v_cvt_f32_i32 v146, v146
v_cvt_f32_i32 v150, v150
v_cvt_f32_i32 v154, v154
v_cvt_f32_i32 v158, v158
v_cvt_f32_i32 v162, v162
v_cvt_f32_i32 v166, v166
v_cvt_f32_i32 v170, v170
buffer_load_dwordx4 v[128:131], v1, s[20:23], s36 offen
v_cvt_f32_i32 v174, v174
v_fma_f32 v146, v146, v82, v86
v_fma_f32 v150, v150, v82, v86
v_fma_f32 v154, v154, v82, v86
v_fma_f32 v158, v158, v82, v86
v_fma_f32 v162, v162, v82, v86
v_fma_f32 v166, v166, v82, v86
v_fma_f32 v170, v170, v82, v86
v_fma_f32 v174, v174, v82, v86
v_mul_f32_dpp v146, v37, v146 row_newbcast:0 row_mask:0xf bank_mask:0xf
v_mul_f32_dpp v150, v37, v150 row_newbcast:1 row_mask:0xf bank_mask:0xf
v_mul_f32_dpp v154, v37, v154 row_newbcast:2 row_mask:0xf bank_mask:0xf
v_mul_f32_dpp v158, v37, v158 row_newbcast:3 row_mask:0xf bank_mask:0xf
v_mul_f32_dpp v162, v37, v162 row_newbcast:4 row_mask:0xf bank_mask:0xf
buffer_load_dwordx4 v[132:135], v1, s[20:23], s37 offen
v_mul_f32_dpp v166, v37, v166 row_newbcast:5 row_mask:0xf bank_mask:0xf
v_mul_f32_dpp v170, v37, v170 row_newbcast:6 row_mask:0xf bank_mask:0xf
v_mul_f32_dpp v174, v37, v174 row_newbcast:7 row_mask:0xf bank_mask:0xf
v_cvt_pk_bf16_f32 v24, v146, v150
v_cvt_pk_bf16_f32 v25, v154, v158
v_cvt_pk_bf16_f32 v26, v162, v166
v_cvt_pk_bf16_f32 v27, v170, v174
ds_write_b128 v4, v[24:27] offset:1024
v_cvt_f32_i32 v147, v147
v_cvt_f32_i32 v151, v151
v_cvt_f32_i32 v155, v155
v_cvt_f32_i32 v159, v159
v_cvt_f32_i32 v163, v163
v_cvt_f32_i32 v167, v167
v_cvt_f32_i32 v171, v171
buffer_load_dwordx4 v[136:139], v1, s[20:23], s38 offen
v_cvt_f32_i32 v175, v175
v_fma_f32 v147, v147, v83, v87
v_fma_f32 v151, v151, v83, v87
v_fma_f32 v155, v155, v83, v87
v_fma_f32 v159, v159, v83, v87
v_fma_f32 v163, v163, v83, v87
v_fma_f32 v167, v167, v83, v87
v_fma_f32 v171, v171, v83, v87
v_fma_f32 v175, v175, v83, v87
v_mul_f32_dpp v147, v37, v147 row_newbcast:0 row_mask:0xf bank_mask:0xf
v_mul_f32_dpp v151, v37, v151 row_newbcast:1 row_mask:0xf bank_mask:0xf
v_mul_f32_dpp v155, v37, v155 row_newbcast:2 row_mask:0xf bank_mask:0xf
v_mul_f32_dpp v159, v37, v159 row_newbcast:3 row_mask:0xf bank_mask:0xf
v_mul_f32_dpp v163, v37, v163 row_newbcast:4 row_mask:0xf bank_mask:0xf
buffer_load_dwordx4 v[140:143], v1, s[20:23], s39 offen
v_mul_f32_dpp v167, v37, v167 row_newbcast:5 row_mask:0xf bank_mask:0xf
v_mul_f32_dpp v171, v37, v171 row_newbcast:6 row_mask:0xf bank_mask:0xf
v_mul_f32_dpp v175, v37, v175 row_newbcast:7 row_mask:0xf bank_mask:0xf
v_cvt_pk_bf16_f32 v28, v147, v151
v_cvt_pk_bf16_f32 v29, v155, v159
v_cvt_pk_bf16_f32 v30, v163, v167
v_cvt_pk_bf16_f32 v31, v171, v175
ds_write_b128 v4, v[28:31] offset:1536
v_lshlrev_b32 v88, 16, v232
v_and_b32 v89, 0xffff0000, v232
v_lshlrev_b32 v92, 16, v234
v_and_b32 v93, 0xffff0000, v234
v_lshlrev_b32 v90, 16, v233
v_and_b32 v91, 0xffff0000, v233
v_lshlrev_b32 v94, 16, v235
v_and_b32 v95, 0xffff0000, v235
v_mul_f32_e64 v92, -v92, v88
v_mul_f32_e64 v93, -v93, v89
v_mul_f32_e64 v94, -v94, v90
v_mul_f32_e64 v95, -v95, v91
s_waitcnt vmcnt(8)
v_cvt_f32_i32 v176, v176
v_cvt_f32_i32 v180, v180
v_cvt_f32_i32 v184, v184
v_cvt_f32_i32 v188, v188
v_cvt_f32_i32 v192, v192
v_cvt_f32_i32 v196, v196
v_cvt_f32_i32 v200, v200
s_bfe_u32 s89, s97, 262164
s_mul_i32 s90, s89, 917504
s_add_u32 s20, s86, s90
s_addc_u32 s21, s87, 0
s_sub_u32 s22, s88, s90
buffer_load_dwordx4 v[144:147], v1, s[20:23], s32 offen
v_cvt_f32_i32 v204, v204
v_fma_f32 v176, v176, v80, v84
v_fma_f32 v180, v180, v80, v84
v_fma_f32 v184, v184, v80, v84
v_fma_f32 v188, v188, v80, v84
v_fma_f32 v192, v192, v80, v84
v_fma_f32 v196, v196, v80, v84
v_fma_f32 v200, v200, v80, v84
v_fma_f32 v204, v204, v80, v84
v_mul_f32_dpp v176, v37, v176 row_newbcast:8 row_mask:0xf bank_mask:0xf
v_mul_f32_dpp v180, v37, v180 row_newbcast:9 row_mask:0xf bank_mask:0xf
v_mul_f32_dpp v184, v37, v184 row_newbcast:10 row_mask:0xf bank_mask:0xf
v_mul_f32_dpp v188, v37, v188 row_newbcast:11 row_mask:0xf bank_mask:0xf
v_mul_f32_dpp v192, v37, v192 row_newbcast:12 row_mask:0xf bank_mask:0xf
buffer_load_dwordx4 v[148:151], v1, s[20:23], s33 offen
v_mul_f32_dpp v196, v37, v196 row_newbcast:13 row_mask:0xf bank_mask:0xf
v_mul_f32_dpp v200, v37, v200 row_newbcast:14 row_mask:0xf bank_mask:0xf
v_mul_f32_dpp v204, v37, v204 row_newbcast:15 row_mask:0xf bank_mask:0xf
v_cvt_pk_bf16_f32 v16, v176, v180
v_cvt_pk_bf16_f32 v17, v184, v188
v_cvt_pk_bf16_f32 v18, v192, v196
v_cvt_pk_bf16_f32 v19, v200, v204
s_waitcnt lgkmcnt(0)
s_barrier
ds_write_b128 v4, v[16:19] offset:16384
v_cvt_f32_i32 v177, v177
v_cvt_f32_i32 v181, v181
v_cvt_f32_i32 v185, v185
v_cvt_f32_i32 v189, v189
v_cvt_f32_i32 v193, v193
v_cvt_f32_i32 v197, v197
v_cvt_f32_i32 v201, v201
buffer_load_dwordx4 v[152:155], v1, s[20:23], s34 offen
v_cvt_f32_i32 v205, v205
v_fma_f32 v177, v177, v81, v85
v_fma_f32 v181, v181, v81, v85
v_fma_f32 v185, v185, v81, v85
v_fma_f32 v189, v189, v81, v85
v_fma_f32 v193, v193, v81, v85
v_fma_f32 v197, v197, v81, v85
v_fma_f32 v201, v201, v81, v85
v_fma_f32 v205, v205, v81, v85
v_mul_f32_dpp v177, v37, v177 row_newbcast:8 row_mask:0xf bank_mask:0xf
v_mul_f32_dpp v181, v37, v181 row_newbcast:9 row_mask:0xf bank_mask:0xf
v_mul_f32_dpp v185, v37, v185 row_newbcast:10 row_mask:0xf bank_mask:0xf
v_mul_f32_dpp v189, v37, v189 row_newbcast:11 row_mask:0xf bank_mask:0xf
v_mul_f32_dpp v193, v37, v193 row_newbcast:12 row_mask:0xf bank_mask:0xf
buffer_load_dwordx4 v[156:159], v1, s[20:23], s35 offen
v_mul_f32_dpp v197, v37, v197 row_newbcast:13 row_mask:0xf bank_mask:0xf
v_mul_f32_dpp v201, v37, v201 row_newbcast:14 row_mask:0xf bank_mask:0xf
v_mul_f32_dpp v205, v37, v205 row_newbcast:15 row_mask:0xf bank_mask:0xf
v_cvt_pk_bf16_f32 v20, v177, v181
v_cvt_pk_bf16_f32 v21, v185, v189
v_cvt_pk_bf16_f32 v22, v193, v197
v_cvt_pk_bf16_f32 v23, v201, v205
ds_write_b128 v4, v[20:23] offset:16896
v_cvt_f32_i32 v178, v178
v_cvt_f32_i32 v182, v182
v_cvt_f32_i32 v186, v186
v_cvt_f32_i32 v190, v190
v_cvt_f32_i32 v194, v194
v_cvt_f32_i32 v198, v198
v_cvt_f32_i32 v202, v202
buffer_load_dwordx4 v[160:163], v1, s[20:23], s36 offen
v_cvt_f32_i32 v206, v206
v_fma_f32 v178, v178, v82, v86
v_fma_f32 v182, v182, v82, v86
v_fma_f32 v186, v186, v82, v86
v_fma_f32 v190, v190, v82, v86
v_fma_f32 v194, v194, v82, v86
v_fma_f32 v198, v198, v82, v86
v_fma_f32 v202, v202, v82, v86
v_fma_f32 v206, v206, v82, v86
v_mul_f32_dpp v178, v37, v178 row_newbcast:8 row_mask:0xf bank_mask:0xf
v_mul_f32_dpp v182, v37, v182 row_newbcast:9 row_mask:0xf bank_mask:0xf
v_mul_f32_dpp v186, v37, v186 row_newbcast:10 row_mask:0xf bank_mask:0xf
v_mul_f32_dpp v190, v37, v190 row_newbcast:11 row_mask:0xf bank_mask:0xf
v_mul_f32_dpp v194, v37, v194 row_newbcast:12 row_mask:0xf bank_mask:0xf
buffer_load_dwordx4 v[164:167], v1, s[20:23], s37 offen
v_mul_f32_dpp v198, v37, v198 row_newbcast:13 row_mask:0xf bank_mask:0xf
v_mul_f32_dpp v202, v37, v202 row_newbcast:14 row_mask:0xf bank_mask:0xf
v_mul_f32_dpp v206, v37, v206 row_newbcast:15 row_mask:0xf bank_mask:0xf
v_cvt_pk_bf16_f32 v24, v178, v182
v_cvt_pk_bf16_f32 v25, v186, v190
v_cvt_pk_bf16_f32 v26, v194, v198
v_cvt_pk_bf16_f32 v27, v202, v206
ds_write_b128 v4, v[24:27] offset:17408
v_cvt_f32_i32 v179, v179
v_cvt_f32_i32 v183, v183
v_cvt_f32_i32 v187, v187
v_cvt_f32_i32 v191, v191
v_cvt_f32_i32 v195, v195
v_cvt_f32_i32 v199, v199
v_cvt_f32_i32 v203, v203
buffer_load_dwordx4 v[168:171], v1, s[20:23], s38 offen
v_cvt_f32_i32 v207, v207
v_fma_f32 v179, v179, v83, v87
v_fma_f32 v183, v183, v83, v87
v_fma_f32 v187, v187, v83, v87
v_fma_f32 v191, v191, v83, v87
v_fma_f32 v195, v195, v83, v87
v_fma_f32 v199, v199, v83, v87
v_fma_f32 v203, v203, v83, v87
v_fma_f32 v207, v207, v83, v87
v_mul_f32_dpp v179, v37, v179 row_newbcast:8 row_mask:0xf bank_mask:0xf
v_mul_f32_dpp v183, v37, v183 row_newbcast:9 row_mask:0xf bank_mask:0xf
v_mul_f32_dpp v187, v37, v187 row_newbcast:10 row_mask:0xf bank_mask:0xf
v_mul_f32_dpp v191, v37, v191 row_newbcast:11 row_mask:0xf bank_mask:0xf
v_mul_f32_dpp v195, v37, v195 row_newbcast:12 row_mask:0xf bank_mask:0xf
buffer_load_dwordx4 v[172:175], v1, s[20:23], s39 offen
v_mul_f32_dpp v199, v37, v199 row_newbcast:13 row_mask:0xf bank_mask:0xf
v_mul_f32_dpp v203, v37, v203 row_newbcast:14 row_mask:0xf bank_mask:0xf
v_mul_f32_dpp v207, v37, v207 row_newbcast:15 row_mask:0xf bank_mask:0xf
v_cvt_pk_bf16_f32 v28, v179, v183
v_cvt_pk_bf16_f32 v29, v187, v191
v_cvt_pk_bf16_f32 v30, v195, v199
v_cvt_pk_bf16_f32 v31, v203, v207
ds_write_b128 v4, v[28:31] offset:17920
s_waitcnt vmcnt(8)
v_cvt_f32_i32 v112, v112
v_cvt_f32_i32 v116, v116
v_cvt_f32_i32 v120, v120
v_cvt_f32_i32 v124, v124
v_cvt_f32_i32 v128, v128
v_cvt_f32_i32 v132, v132
v_cvt_f32_i32 v136, v136
s_bfe_u32 s89, s97, 262168
s_mul_i32 s90, s89, 917504
s_add_u32 s20, s86, s90
s_addc_u32 s21, s87, 0
s_sub_u32 s22, s88, s90
buffer_load_dwordx4 v[176:179], v1, s[20:23], s32 offen
v_cvt_f32_i32 v140, v140
v_fma_f32 v112, v112, v88, v92
v_fma_f32 v116, v116, v88, v92
v_fma_f32 v120, v120, v88, v92
v_fma_f32 v124, v124, v88, v92
v_fma_f32 v128, v128, v88, v92
v_fma_f32 v132, v132, v88, v92
v_fma_f32 v136, v136, v88, v92
v_fma_f32 v140, v140, v88, v92
v_mul_f32_dpp v112, v38, v112 row_newbcast:0 row_mask:0xf bank_mask:0xf
v_mul_f32_dpp v116, v38, v116 row_newbcast:1 row_mask:0xf bank_mask:0xf
v_mul_f32_dpp v120, v38, v120 row_newbcast:2 row_mask:0xf bank_mask:0xf
v_mul_f32_dpp v124, v38, v124 row_newbcast:3 row_mask:0xf bank_mask:0xf
v_mul_f32_dpp v128, v38, v128 row_newbcast:4 row_mask:0xf bank_mask:0xf
buffer_load_dwordx4 v[180:183], v1, s[20:23], s33 offen
v_mul_f32_dpp v132, v38, v132 row_newbcast:5 row_mask:0xf bank_mask:0xf
v_mul_f32_dpp v136, v38, v136 row_newbcast:6 row_mask:0xf bank_mask:0xf
v_mul_f32_dpp v140, v38, v140 row_newbcast:7 row_mask:0xf bank_mask:0xf
v_cvt_pk_bf16_f32 v16, v112, v116
v_cvt_pk_bf16_f32 v17, v120, v124
v_cvt_pk_bf16_f32 v18, v128, v132
v_cvt_pk_bf16_f32 v19, v136, v140
s_waitcnt lgkmcnt(0)
s_barrier
ds_write_b128 v4, v[16:19] offset:0
v_cvt_f32_i32 v113, v113
v_cvt_f32_i32 v117, v117
v_cvt_f32_i32 v121, v121
v_cvt_f32_i32 v125, v125
v_cvt_f32_i32 v129, v129
v_cvt_f32_i32 v133, v133
v_cvt_f32_i32 v137, v137
buffer_load_dwordx4 v[184:187], v1, s[20:23], s34 offen
v_cvt_f32_i32 v141, v141
v_fma_f32 v113, v113, v89, v93
v_fma_f32 v117, v117, v89, v93
v_fma_f32 v121, v121, v89, v93
v_fma_f32 v125, v125, v89, v93
v_fma_f32 v129, v129, v89, v93
v_fma_f32 v133, v133, v89, v93
v_fma_f32 v137, v137, v89, v93
v_fma_f32 v141, v141, v89, v93
v_mul_f32_dpp v113, v38, v113 row_newbcast:0 row_mask:0xf bank_mask:0xf
v_mul_f32_dpp v117, v38, v117 row_newbcast:1 row_mask:0xf bank_mask:0xf
v_mul_f32_dpp v121, v38, v121 row_newbcast:2 row_mask:0xf bank_mask:0xf
v_mul_f32_dpp v125, v38, v125 row_newbcast:3 row_mask:0xf bank_mask:0xf
v_mul_f32_dpp v129, v38, v129 row_newbcast:4 row_mask:0xf bank_mask:0xf
buffer_load_dwordx4 v[188:191], v1, s[20:23], s35 offen
v_mul_f32_dpp v133, v38, v133 row_newbcast:5 row_mask:0xf bank_mask:0xf
v_mul_f32_dpp v137, v38, v137 row_newbcast:6 row_mask:0xf bank_mask:0xf
v_mul_f32_dpp v141, v38, v141 row_newbcast:7 row_mask:0xf bank_mask:0xf
v_cvt_pk_bf16_f32 v20, v113, v117
v_cvt_pk_bf16_f32 v21, v121, v125
v_cvt_pk_bf16_f32 v22, v129, v133
v_cvt_pk_bf16_f32 v23, v137, v141
ds_write_b128 v4, v[20:23] offset:512
v_cvt_f32_i32 v114, v114
v_cvt_f32_i32 v118, v118
v_cvt_f32_i32 v122, v122
v_cvt_f32_i32 v126, v126
v_cvt_f32_i32 v130, v130
v_cvt_f32_i32 v134, v134
v_cvt_f32_i32 v138, v138
buffer_load_dwordx4 v[192:195], v1, s[20:23], s36 offen
v_cvt_f32_i32 v142, v142
v_fma_f32 v114, v114, v90, v94
v_fma_f32 v118, v118, v90, v94
v_fma_f32 v122, v122, v90, v94
v_fma_f32 v126, v126, v90, v94
v_fma_f32 v130, v130, v90, v94
v_fma_f32 v134, v134, v90, v94
v_fma_f32 v138, v138, v90, v94
v_fma_f32 v142, v142, v90, v94
v_mul_f32_dpp v114, v38, v114 row_newbcast:0 row_mask:0xf bank_mask:0xf
v_mul_f32_dpp v118, v38, v118 row_newbcast:1 row_mask:0xf bank_mask:0xf
v_mul_f32_dpp v122, v38, v122 row_newbcast:2 row_mask:0xf bank_mask:0xf
v_mul_f32_dpp v126, v38, v126 row_newbcast:3 row_mask:0xf bank_mask:0xf
v_mul_f32_dpp v130, v38, v130 row_newbcast:4 row_mask:0xf bank_mask:0xf
buffer_load_dwordx4 v[196:199], v1, s[20:23], s37 offen
v_mul_f32_dpp v134, v38, v134 row_newbcast:5 row_mask:0xf bank_mask:0xf
v_mul_f32_dpp v138, v38, v138 row_newbcast:6 row_mask:0xf bank_mask:0xf
v_mul_f32_dpp v142, v38, v142 row_newbcast:7 row_mask:0xf bank_mask:0xf
v_cvt_pk_bf16_f32 v24, v114, v118
v_cvt_pk_bf16_f32 v25, v122, v126
v_cvt_pk_bf16_f32 v26, v130, v134
v_cvt_pk_bf16_f32 v27, v138, v142
ds_write_b128 v4, v[24:27] offset:1024
v_cvt_f32_i32 v115, v115
v_cvt_f32_i32 v119, v119
v_cvt_f32_i32 v123, v123
v_cvt_f32_i32 v127, v127
v_cvt_f32_i32 v131, v131
v_cvt_f32_i32 v135, v135
v_cvt_f32_i32 v139, v139
buffer_load_dwordx4 v[200:203], v1, s[20:23], s38 offen
v_cvt_f32_i32 v143, v143
v_fma_f32 v115, v115, v91, v95
v_fma_f32 v119, v119, v91, v95
v_fma_f32 v123, v123, v91, v95
v_fma_f32 v127, v127, v91, v95
v_fma_f32 v131, v131, v91, v95
v_fma_f32 v135, v135, v91, v95
v_fma_f32 v139, v139, v91, v95
v_fma_f32 v143, v143, v91, v95
v_mul_f32_dpp v115, v38, v115 row_newbcast:0 row_mask:0xf bank_mask:0xf
v_mul_f32_dpp v119, v38, v119 row_newbcast:1 row_mask:0xf bank_mask:0xf
v_mul_f32_dpp v123, v38, v123 row_newbcast:2 row_mask:0xf bank_mask:0xf
v_mul_f32_dpp v127, v38, v127 row_newbcast:3 row_mask:0xf bank_mask:0xf
v_mul_f32_dpp v131, v38, v131 row_newbcast:4 row_mask:0xf bank_mask:0xf
buffer_load_dwordx4 v[204:207], v1, s[20:23], s39 offen
v_mul_f32_dpp v135, v38, v135 row_newbcast:5 row_mask:0xf bank_mask:0xf
v_mul_f32_dpp v139, v38, v139 row_newbcast:6 row_mask:0xf bank_mask:0xf
v_mul_f32_dpp v143, v38, v143 row_newbcast:7 row_mask:0xf bank_mask:0xf
v_cvt_pk_bf16_f32 v28, v115, v119
v_cvt_pk_bf16_f32 v29, v123, v127
v_cvt_pk_bf16_f32 v30, v131, v135
v_cvt_pk_bf16_f32 v31, v139, v143
ds_write_b128 v4, v[28:31] offset:1536
v_lshlrev_b32 v96, 16, v236
v_and_b32 v97, 0xffff0000, v236
v_lshlrev_b32 v100, 16, v238
v_and_b32 v101, 0xffff0000, v238
v_lshlrev_b32 v98, 16, v237
v_and_b32 v99, 0xffff0000, v237
v_lshlrev_b32 v102, 16, v239
v_and_b32 v103, 0xffff0000, v239
v_mul_f32_e64 v100, -v100, v96
v_mul_f32_e64 v101, -v101, v97
v_mul_f32_e64 v102, -v102, v98
v_mul_f32_e64 v103, -v103, v99
s_waitcnt vmcnt(8)
v_cvt_f32_i32 v144, v144
v_cvt_f32_i32 v148, v148
v_cvt_f32_i32 v152, v152
v_cvt_f32_i32 v156, v156
v_cvt_f32_i32 v160, v160
v_cvt_f32_i32 v164, v164
v_cvt_f32_i32 v168, v168
s_bfe_u32 s89, s97, 262172
s_mul_i32 s90, s89, 917504
s_add_u32 s20, s86, s90
s_addc_u32 s21, s87, 0
s_sub_u32 s22, s88, s90
buffer_load_dwordx4 v[112:115], v1, s[20:23], s32 offen
v_cvt_f32_i32 v172, v172
v_fma_f32 v144, v144, v88, v92
v_fma_f32 v148, v148, v88, v92
v_fma_f32 v152, v152, v88, v92
v_fma_f32 v156, v156, v88, v92
v_fma_f32 v160, v160, v88, v92
v_fma_f32 v164, v164, v88, v92
v_fma_f32 v168, v168, v88, v92
v_fma_f32 v172, v172, v88, v92
v_mul_f32_dpp v144, v38, v144 row_newbcast:8 row_mask:0xf bank_mask:0xf
v_mul_f32_dpp v148, v38, v148 row_newbcast:9 row_mask:0xf bank_mask:0xf
v_mul_f32_dpp v152, v38, v152 row_newbcast:10 row_mask:0xf bank_mask:0xf
v_mul_f32_dpp v156, v38, v156 row_newbcast:11 row_mask:0xf bank_mask:0xf
v_mul_f32_dpp v160, v38, v160 row_newbcast:12 row_mask:0xf bank_mask:0xf
buffer_load_dwordx4 v[116:119], v1, s[20:23], s33 offen
v_mul_f32_dpp v164, v38, v164 row_newbcast:13 row_mask:0xf bank_mask:0xf
v_mul_f32_dpp v168, v38, v168 row_newbcast:14 row_mask:0xf bank_mask:0xf
v_mul_f32_dpp v172, v38, v172 row_newbcast:15 row_mask:0xf bank_mask:0xf
v_cvt_pk_bf16_f32 v16, v144, v148
v_cvt_pk_bf16_f32 v17, v152, v156
v_cvt_pk_bf16_f32 v18, v160, v164
v_cvt_pk_bf16_f32 v19, v168, v172
s_waitcnt lgkmcnt(0)
s_barrier
ds_write_b128 v4, v[16:19] offset:16384
v_cvt_f32_i32 v145, v145
v_cvt_f32_i32 v149, v149
v_cvt_f32_i32 v153, v153
v_cvt_f32_i32 v157, v157
v_cvt_f32_i32 v161, v161
v_cvt_f32_i32 v165, v165
v_cvt_f32_i32 v169, v169
buffer_load_dwordx4 v[120:123], v1, s[20:23], s34 offen
v_cvt_f32_i32 v173, v173
v_fma_f32 v145, v145, v89, v93
v_fma_f32 v149, v149, v89, v93
v_fma_f32 v153, v153, v89, v93
v_fma_f32 v157, v157, v89, v93
v_fma_f32 v161, v161, v89, v93
v_fma_f32 v165, v165, v89, v93
v_fma_f32 v169, v169, v89, v93
v_fma_f32 v173, v173, v89, v93
v_mul_f32_dpp v145, v38, v145 row_newbcast:8 row_mask:0xf bank_mask:0xf
v_mul_f32_dpp v149, v38, v149 row_newbcast:9 row_mask:0xf bank_mask:0xf
v_mul_f32_dpp v153, v38, v153 row_newbcast:10 row_mask:0xf bank_mask:0xf
v_mul_f32_dpp v157, v38, v157 row_newbcast:11 row_mask:0xf bank_mask:0xf
v_mul_f32_dpp v161, v38, v161 row_newbcast:12 row_mask:0xf bank_mask:0xf
buffer_load_dwordx4 v[124:127], v1, s[20:23], s35 offen
v_mul_f32_dpp v165, v38, v165 row_newbcast:13 row_mask:0xf bank_mask:0xf
v_mul_f32_dpp v169, v38, v169 row_newbcast:14 row_mask:0xf bank_mask:0xf
v_mul_f32_dpp v173, v38, v173 row_newbcast:15 row_mask:0xf bank_mask:0xf
v_cvt_pk_bf16_f32 v20, v145, v149
v_cvt_pk_bf16_f32 v21, v153, v157
v_cvt_pk_bf16_f32 v22, v161, v165
v_cvt_pk_bf16_f32 v23, v169, v173
ds_write_b128 v4, v[20:23] offset:16896
v_cvt_f32_i32 v146, v146
v_cvt_f32_i32 v150, v150
v_cvt_f32_i32 v154, v154
v_cvt_f32_i32 v158, v158
v_cvt_f32_i32 v162, v162
v_cvt_f32_i32 v166, v166
v_cvt_f32_i32 v170, v170
buffer_load_dwordx4 v[128:131], v1, s[20:23], s36 offen
v_cvt_f32_i32 v174, v174
v_fma_f32 v146, v146, v90, v94
v_fma_f32 v150, v150, v90, v94
v_fma_f32 v154, v154, v90, v94
v_fma_f32 v158, v158, v90, v94
v_fma_f32 v162, v162, v90, v94
v_fma_f32 v166, v166, v90, v94
v_fma_f32 v170, v170, v90, v94
v_fma_f32 v174, v174, v90, v94
v_mul_f32_dpp v146, v38, v146 row_newbcast:8 row_mask:0xf bank_mask:0xf
v_mul_f32_dpp v150, v38, v150 row_newbcast:9 row_mask:0xf bank_mask:0xf
v_mul_f32_dpp v154, v38, v154 row_newbcast:10 row_mask:0xf bank_mask:0xf
v_mul_f32_dpp v158, v38, v158 row_newbcast:11 row_mask:0xf bank_mask:0xf
v_mul_f32_dpp v162, v38, v162 row_newbcast:12 row_mask:0xf bank_mask:0xf
buffer_load_dwordx4 v[132:135], v1, s[20:23], s37 offen
v_mul_f32_dpp v166, v38, v166 row_newbcast:13 row_mask:0xf bank_mask:0xf
v_mul_f32_dpp v170, v38, v170 row_newbcast:14 row_mask:0xf bank_mask:0xf
v_mul_f32_dpp v174, v38, v174 row_newbcast:15 row_mask:0xf bank_mask:0xf
v_cvt_pk_bf16_f32 v24, v146, v150
v_cvt_pk_bf16_f32 v25, v154, v158
v_cvt_pk_bf16_f32 v26, v162, v166
v_cvt_pk_bf16_f32 v27, v170, v174
ds_write_b128 v4, v[24:27] offset:17408
v_cvt_f32_i32 v147, v147
v_cvt_f32_i32 v151, v151
v_cvt_f32_i32 v155, v155
v_cvt_f32_i32 v159, v159
v_cvt_f32_i32 v163, v163
v_cvt_f32_i32 v167, v167
v_cvt_f32_i32 v171, v171
buffer_load_dwordx4 v[136:139], v1, s[20:23], s38 offen
v_cvt_f32_i32 v175, v175
v_fma_f32 v147, v147, v91, v95
v_fma_f32 v151, v151, v91, v95
v_fma_f32 v155, v155, v91, v95
v_fma_f32 v159, v159, v91, v95
v_fma_f32 v163, v163, v91, v95
v_fma_f32 v167, v167, v91, v95
v_fma_f32 v171, v171, v91, v95
v_fma_f32 v175, v175, v91, v95
v_mul_f32_dpp v147, v38, v147 row_newbcast:8 row_mask:0xf bank_mask:0xf
v_mul_f32_dpp v151, v38, v151 row_newbcast:9 row_mask:0xf bank_mask:0xf
v_mul_f32_dpp v155, v38, v155 row_newbcast:10 row_mask:0xf bank_mask:0xf
v_mul_f32_dpp v159, v38, v159 row_newbcast:11 row_mask:0xf bank_mask:0xf
v_mul_f32_dpp v163, v38, v163 row_newbcast:12 row_mask:0xf bank_mask:0xf
buffer_load_dwordx4 v[140:143], v1, s[20:23], s39 offen
v_mul_f32_dpp v167, v38, v167 row_newbcast:13 row_mask:0xf bank_mask:0xf
v_mul_f32_dpp v171, v38, v171 row_newbcast:14 row_mask:0xf bank_mask:0xf
v_mul_f32_dpp v175, v38, v175 row_newbcast:15 row_mask:0xf bank_mask:0xf
v_cvt_pk_bf16_f32 v28, v147, v151
v_cvt_pk_bf16_f32 v29, v155, v159
v_cvt_pk_bf16_f32 v30, v163, v167
v_cvt_pk_bf16_f32 v31, v171, v175
ds_write_b128 v4, v[28:31] offset:17920
s_waitcnt vmcnt(8)
v_cvt_f32_i32 v176, v176
v_cvt_f32_i32 v180, v180
v_cvt_f32_i32 v184, v184
v_cvt_f32_i32 v188, v188
v_cvt_f32_i32 v192, v192
v_cvt_f32_i32 v196, v196
v_cvt_f32_i32 v200, v200
v_cvt_f32_i32 v204, v204
v_fma_f32 v176, v176, v96, v100
v_fma_f32 v180, v180, v96, v100
v_fma_f32 v184, v184, v96, v100
v_fma_f32 v188, v188, v96, v100
v_fma_f32 v192, v192, v96, v100
v_fma_f32 v196, v196, v96, v100
v_fma_f32 v200, v200, v96, v100
v_fma_f32 v204, v204, v96, v100
v_mul_f32_dpp v176, v39, v176 row_newbcast:0 row_mask:0xf bank_mask:0xf
v_mul_f32_dpp v180, v39, v180 row_newbcast:1 row_mask:0xf bank_mask:0xf
v_mul_f32_dpp v184, v39, v184 row_newbcast:2 row_mask:0xf bank_mask:0xf
v_mul_f32_dpp v188, v39, v188 row_newbcast:3 row_mask:0xf bank_mask:0xf
v_mul_f32_dpp v192, v39, v192 row_newbcast:4 row_mask:0xf bank_mask:0xf
v_mul_f32_dpp v196, v39, v196 row_newbcast:5 row_mask:0xf bank_mask:0xf
v_mul_f32_dpp v200, v39, v200 row_newbcast:6 row_mask:0xf bank_mask:0xf
v_mul_f32_dpp v204, v39, v204 row_newbcast:7 row_mask:0xf bank_mask:0xf
v_cvt_pk_bf16_f32 v16, v176, v180
v_cvt_pk_bf16_f32 v17, v184, v188
v_cvt_pk_bf16_f32 v18, v192, v196
v_cvt_pk_bf16_f32 v19, v200, v204
s_waitcnt lgkmcnt(0)
s_barrier
ds_write_b128 v4, v[16:19] offset:0
v_cvt_f32_i32 v177, v177
v_cvt_f32_i32 v181, v181
v_cvt_f32_i32 v185, v185
v_cvt_f32_i32 v189, v189
v_cvt_f32_i32 v193, v193
v_cvt_f32_i32 v197, v197
v_cvt_f32_i32 v201, v201
v_cvt_f32_i32 v205, v205
v_fma_f32 v177, v177, v97, v101
v_fma_f32 v181, v181, v97, v101
v_fma_f32 v185, v185, v97, v101
v_fma_f32 v189, v189, v97, v101
v_fma_f32 v193, v193, v97, v101
v_fma_f32 v197, v197, v97, v101
v_fma_f32 v201, v201, v97, v101
v_fma_f32 v205, v205, v97, v101
v_mul_f32_dpp v177, v39, v177 row_newbcast:0 row_mask:0xf bank_mask:0xf
v_mul_f32_dpp v181, v39, v181 row_newbcast:1 row_mask:0xf bank_mask:0xf
v_mul_f32_dpp v185, v39, v185 row_newbcast:2 row_mask:0xf bank_mask:0xf
v_mul_f32_dpp v189, v39, v189 row_newbcast:3 row_mask:0xf bank_mask:0xf
v_mul_f32_dpp v193, v39, v193 row_newbcast:4 row_mask:0xf bank_mask:0xf
v_mul_f32_dpp v197, v39, v197 row_newbcast:5 row_mask:0xf bank_mask:0xf
v_mul_f32_dpp v201, v39, v201 row_newbcast:6 row_mask:0xf bank_mask:0xf
v_mul_f32_dpp v205, v39, v205 row_newbcast:7 row_mask:0xf bank_mask:0xf
v_cvt_pk_bf16_f32 v20, v177, v181
v_cvt_pk_bf16_f32 v21, v185, v189
v_cvt_pk_bf16_f32 v22, v193, v197
v_cvt_pk_bf16_f32 v23, v201, v205
ds_write_b128 v4, v[20:23] offset:512
v_cvt_f32_i32 v178, v178
v_cvt_f32_i32 v182, v182
v_cvt_f32_i32 v186, v186
v_cvt_f32_i32 v190, v190
v_cvt_f32_i32 v194, v194
v_cvt_f32_i32 v198, v198
v_cvt_f32_i32 v202, v202
v_cvt_f32_i32 v206, v206
v_fma_f32 v178, v178, v98, v102
v_fma_f32 v182, v182, v98, v102
v_fma_f32 v186, v186, v98, v102
v_fma_f32 v190, v190, v98, v102
v_fma_f32 v194, v194, v98, v102
v_fma_f32 v198, v198, v98, v102
v_fma_f32 v202, v202, v98, v102
v_fma_f32 v206, v206, v98, v102
v_mul_f32_dpp v178, v39, v178 row_newbcast:0 row_mask:0xf bank_mask:0xf
v_mul_f32_dpp v182, v39, v182 row_newbcast:1 row_mask:0xf bank_mask:0xf
v_mul_f32_dpp v186, v39, v186 row_newbcast:2 row_mask:0xf bank_mask:0xf
v_mul_f32_dpp v190, v39, v190 row_newbcast:3 row_mask:0xf bank_mask:0xf
v_mul_f32_dpp v194, v39, v194 row_newbcast:4 row_mask:0xf bank_mask:0xf
v_mul_f32_dpp v198, v39, v198 row_newbcast:5 row_mask:0xf bank_mask:0xf
v_mul_f32_dpp v202, v39, v202 row_newbcast:6 row_mask:0xf bank_mask:0xf
v_mul_f32_dpp v206, v39, v206 row_newbcast:7 row_mask:0xf bank_mask:0xf
v_cvt_pk_bf16_f32 v24, v178, v182
v_cvt_pk_bf16_f32 v25, v186, v190
v_cvt_pk_bf16_f32 v26, v194, v198
v_cvt_pk_bf16_f32 v27, v202, v206
ds_write_b128 v4, v[24:27] offset:1024
v_cvt_f32_i32 v179, v179
v_cvt_f32_i32 v183, v183
v_cvt_f32_i32 v187, v187
v_cvt_f32_i32 v191, v191
v_cvt_f32_i32 v195, v195
v_cvt_f32_i32 v199, v199
v_cvt_f32_i32 v203, v203
v_cvt_f32_i32 v207, v207
v_fma_f32 v179, v179, v99, v103
v_fma_f32 v183, v183, v99, v103
v_fma_f32 v187, v187, v99, v103
v_fma_f32 v191, v191, v99, v103
v_fma_f32 v195, v195, v99, v103
v_fma_f32 v199, v199, v99, v103
v_fma_f32 v203, v203, v99, v103
v_fma_f32 v207, v207, v99, v103
v_mul_f32_dpp v179, v39, v179 row_newbcast:0 row_mask:0xf bank_mask:0xf
v_mul_f32_dpp v183, v39, v183 row_newbcast:1 row_mask:0xf bank_mask:0xf
v_mul_f32_dpp v187, v39, v187 row_newbcast:2 row_mask:0xf bank_mask:0xf
v_mul_f32_dpp v191, v39, v191 row_newbcast:3 row_mask:0xf bank_mask:0xf
v_mul_f32_dpp v195, v39, v195 row_newbcast:4 row_mask:0xf bank_mask:0xf
v_mul_f32_dpp v199, v39, v199 row_newbcast:5 row_mask:0xf bank_mask:0xf
v_mul_f32_dpp v203, v39, v203 row_newbcast:6 row_mask:0xf bank_mask:0xf
v_mul_f32_dpp v207, v39, v207 row_newbcast:7 row_mask:0xf bank_mask:0xf
v_cvt_pk_bf16_f32 v28, v179, v183
v_cvt_pk_bf16_f32 v29, v187, v191
v_cvt_pk_bf16_f32 v30, v195, v199
v_cvt_pk_bf16_f32 v31, v203, v207
ds_write_b128 v4, v[28:31] offset:1536
s_waitcnt vmcnt(0)
v_cvt_f32_i32 v112, v112
v_cvt_f32_i32 v116, v116
v_cvt_f32_i32 v120, v120
v_cvt_f32_i32 v124, v124
v_cvt_f32_i32 v128, v128
v_cvt_f32_i32 v132, v132
v_cvt_f32_i32 v136, v136
v_cvt_f32_i32 v140, v140
v_fma_f32 v112, v112, v96, v100
v_fma_f32 v116, v116, v96, v100
v_fma_f32 v120, v120, v96, v100
v_fma_f32 v124, v124, v96, v100
v_fma_f32 v128, v128, v96, v100
v_fma_f32 v132, v132, v96, v100
v_fma_f32 v136, v136, v96, v100
v_fma_f32 v140, v140, v96, v100
v_mul_f32_dpp v112, v39, v112 row_newbcast:8 row_mask:0xf bank_mask:0xf
v_mul_f32_dpp v116, v39, v116 row_newbcast:9 row_mask:0xf bank_mask:0xf
v_mul_f32_dpp v120, v39, v120 row_newbcast:10 row_mask:0xf bank_mask:0xf
v_mul_f32_dpp v124, v39, v124 row_newbcast:11 row_mask:0xf bank_mask:0xf
v_mul_f32_dpp v128, v39, v128 row_newbcast:12 row_mask:0xf bank_mask:0xf
v_mul_f32_dpp v132, v39, v132 row_newbcast:13 row_mask:0xf bank_mask:0xf
v_mul_f32_dpp v136, v39, v136 row_newbcast:14 row_mask:0xf bank_mask:0xf
v_mul_f32_dpp v140, v39, v140 row_newbcast:15 row_mask:0xf bank_mask:0xf
v_cvt_pk_bf16_f32 v16, v112, v116
v_cvt_pk_bf16_f32 v17, v120, v124
v_cvt_pk_bf16_f32 v18, v128, v132
v_cvt_pk_bf16_f32 v19, v136, v140
s_waitcnt lgkmcnt(0)
s_barrier
ds_write_b128 v4, v[16:19] offset:16384
v_cvt_f32_i32 v113, v113
v_cvt_f32_i32 v117, v117
v_cvt_f32_i32 v121, v121
v_cvt_f32_i32 v125, v125
v_cvt_f32_i32 v129, v129
v_cvt_f32_i32 v133, v133
v_cvt_f32_i32 v137, v137
v_cvt_f32_i32 v141, v141
v_fma_f32 v113, v113, v97, v101
v_fma_f32 v117, v117, v97, v101
v_fma_f32 v121, v121, v97, v101
v_fma_f32 v125, v125, v97, v101
v_fma_f32 v129, v129, v97, v101
v_fma_f32 v133, v133, v97, v101
v_fma_f32 v137, v137, v97, v101
v_fma_f32 v141, v141, v97, v101
v_mul_f32_dpp v113, v39, v113 row_newbcast:8 row_mask:0xf bank_mask:0xf
v_mul_f32_dpp v117, v39, v117 row_newbcast:9 row_mask:0xf bank_mask:0xf
v_mul_f32_dpp v121, v39, v121 row_newbcast:10 row_mask:0xf bank_mask:0xf
v_mul_f32_dpp v125, v39, v125 row_newbcast:11 row_mask:0xf bank_mask:0xf
v_mul_f32_dpp v129, v39, v129 row_newbcast:12 row_mask:0xf bank_mask:0xf
v_mul_f32_dpp v133, v39, v133 row_newbcast:13 row_mask:0xf bank_mask:0xf
v_mul_f32_dpp v137, v39, v137 row_newbcast:14 row_mask:0xf bank_mask:0xf
v_mul_f32_dpp v141, v39, v141 row_newbcast:15 row_mask:0xf bank_mask:0xf
v_cvt_pk_bf16_f32 v20, v113, v117
v_cvt_pk_bf16_f32 v21, v121, v125
v_cvt_pk_bf16_f32 v22, v129, v133
v_cvt_pk_bf16_f32 v23, v137, v141
ds_write_b128 v4, v[20:23] offset:16896
v_cvt_f32_i32 v114, v114
v_cvt_f32_i32 v118, v118
v_cvt_f32_i32 v122, v122
v_cvt_f32_i32 v126, v126
v_cvt_f32_i32 v130, v130
v_cvt_f32_i32 v134, v134
v_cvt_f32_i32 v138, v138
v_cvt_f32_i32 v142, v142
v_fma_f32 v114, v114, v98, v102
v_fma_f32 v118, v118, v98, v102
v_fma_f32 v122, v122, v98, v102
v_fma_f32 v126, v126, v98, v102
v_fma_f32 v130, v130, v98, v102
v_fma_f32 v134, v134, v98, v102
v_fma_f32 v138, v138, v98, v102
v_fma_f32 v142, v142, v98, v102
v_mul_f32_dpp v114, v39, v114 row_newbcast:8 row_mask:0xf bank_mask:0xf
v_mul_f32_dpp v118, v39, v118 row_newbcast:9 row_mask:0xf bank_mask:0xf
v_mul_f32_dpp v122, v39, v122 row_newbcast:10 row_mask:0xf bank_mask:0xf
v_mul_f32_dpp v126, v39, v126 row_newbcast:11 row_mask:0xf bank_mask:0xf
v_mul_f32_dpp v130, v39, v130 row_newbcast:12 row_mask:0xf bank_mask:0xf
v_mul_f32_dpp v134, v39, v134 row_newbcast:13 row_mask:0xf bank_mask:0xf
v_mul_f32_dpp v138, v39, v138 row_newbcast:14 row_mask:0xf bank_mask:0xf
v_mul_f32_dpp v142, v39, v142 row_newbcast:15 row_mask:0xf bank_mask:0xf
v_cvt_pk_bf16_f32 v24, v114, v118
v_cvt_pk_bf16_f32 v25, v122, v126
v_cvt_pk_bf16_f32 v26, v130, v134
v_cvt_pk_bf16_f32 v27, v138, v142
ds_write_b128 v4, v[24:27] offset:17408
v_cvt_f32_i32 v115, v115
v_cvt_f32_i32 v119, v119
v_cvt_f32_i32 v123, v123
v_cvt_f32_i32 v127, v127
v_cvt_f32_i32 v131, v131
v_cvt_f32_i32 v135, v135
v_cvt_f32_i32 v139, v139
v_cvt_f32_i32 v143, v143
v_fma_f32 v115, v115, v99, v103
v_fma_f32 v119, v119, v99, v103
v_fma_f32 v123, v123, v99, v103
v_fma_f32 v127, v127, v99, v103
v_fma_f32 v131, v131, v99, v103
v_fma_f32 v135, v135, v99, v103
v_fma_f32 v139, v139, v99, v103
v_fma_f32 v143, v143, v99, v103
v_mul_f32_dpp v115, v39, v115 row_newbcast:8 row_mask:0xf bank_mask:0xf
v_mul_f32_dpp v119, v39, v119 row_newbcast:9 row_mask:0xf bank_mask:0xf
v_mul_f32_dpp v123, v39, v123 row_newbcast:10 row_mask:0xf bank_mask:0xf
v_mul_f32_dpp v127, v39, v127 row_newbcast:11 row_mask:0xf bank_mask:0xf
v_mul_f32_dpp v131, v39, v131 row_newbcast:12 row_mask:0xf bank_mask:0xf
v_mul_f32_dpp v135, v39, v135 row_newbcast:13 row_mask:0xf bank_mask:0xf
v_mul_f32_dpp v139, v39, v139 row_newbcast:14 row_mask:0xf bank_mask:0xf
v_mul_f32_dpp v143, v39, v143 row_newbcast:15 row_mask:0xf bank_mask:0xf
v_cvt_pk_bf16_f32 v28, v115, v119
v_cvt_pk_bf16_f32 v29, v123, v127
v_cvt_pk_bf16_f32 v30, v131, v135
v_cvt_pk_bf16_f32 v31, v139, v143
ds_write_b128 v4, v[28:31] offset:17920
s_waitcnt lgkmcnt(0)
s_barrier
s_endpgm
L_end:
s_endpgm
.section .rodata,"a"
.p2align 6
.amdhsa_kernel standalone__weight_only_int_omniquant__prompt_kernel
  .amdhsa_next_free_vgpr 256
  .amdhsa_next_free_sgpr 100
  .amdhsa_accum_offset 256
  .amdhsa_group_segment_fixed_size 0
  .amdhsa_kernarg_size 64
  .amdhsa_user_sgpr_count 2
  .amdhsa_user_sgpr_kernarg_segment_ptr 1
  .amdhsa_system_sgpr_workgroup_id_x 1
  .amdhsa_float_denorm_mode_32 3
.end_amdhsa_kernel
```
